```python
import torch

def _softmax(x, axis=-1):
    return torch.softmax(x, dim=axis)
def _gelu(x):
    return torch.nn.functional.gelu(x, approximate="tanh")
def _silu(x):
    return torch.nn.functional.silu(x)
def _sigmoid(x):
    return torch.sigmoid(x)
def _layernorm(x, axis=-1, eps=1e-5):
    m = x.mean(dim=axis, keepdim=True)
    v = x.var(dim=axis, keepdim=True, unbiased=False)
    return (x - m) / torch.sqrt(v + eps)
def _scatter_add(tgt, idx, src, axis=0):
    return tgt.clone().index_add_(axis, idx, src)
def _segment_sum(src, seg, n):
    out = torch.zeros((n,) + src.shape[1:], dtype=src.dtype)
    return out.index_add_(0, seg, src)
def _pad(x, pw):
    flat = tuple(v for pair in reversed(pw) for v in pair)
    return torch.nn.functional.pad(x, flat)

kernel_name = 'concat_heads__grouped_kv_mqa__sliding_local_dilated__prompt'

def setup_inputs():

    _w = (lambda a: (lambda t: t.to(torch.bfloat16) if t.is_floating_point() else t)(torch.as_tensor(a)))
    def _A_setup():
        B, S, D, H = 1, 2048, 512, 32
        Dh = D // H
        return {
            "x": _w((lambda *s: torch.randn(*s, dtype=torch.bfloat16) * 0.05)(B, S, D)),
            "wq": _w((lambda *s: torch.randn(*s, dtype=torch.bfloat16) * 3.2)(D, H * Dh)),
            "wk": _w((lambda *s: torch.randn(*s, dtype=torch.bfloat16) * 3.2)(D, Dh)),
            "wv": _w((lambda *s: torch.randn(*s, dtype=torch.bfloat16) * 1.6)(D, Dh)),
            "wo": _w((lambda *s: torch.randn(*s, dtype=torch.bfloat16) * 1.6)(H * Dh, D)),
        }
    _A_in = _A_setup()

    def _B_setup():
        B, S, D = 1, 2048, 512
        return {
            "x": _w((lambda *s: torch.randn(*s, dtype=torch.bfloat16) * 0.1)(B, S, D)),
            "wqkv": _w((lambda *s: torch.randn(*s, dtype=torch.bfloat16) * 0.8)(D, 3 * D)),
            "wo": _w((lambda *s: torch.randn(*s, dtype=torch.bfloat16) * 0.8)(D, D)),
        }
    _B_in = _B_setup()

    return {
        "A_x": _A_in["x"],
        "A_wq": _A_in["wq"],
        "A_wk": _A_in["wk"],
        "A_wv": _A_in["wv"],
        "A_wo": _A_in["wo"],
        "B_x": _B_in["x"],
        "B_wqkv": _B_in["wqkv"],
        "B_wo": _B_in["wo"],
    }

def reference(A_x, A_wq, A_wk, A_wv, A_wo, B_x, B_wqkv, B_wo):
    def _A_ref(x, wq, wk, wv, wo):
        B, S, D = x.shape
        H = 32
        Dh = D // H
        q = (lambda x, *d: x.permute(*d))((x @ wq).reshape(B, S, H, Dh), 0, 2, 1, 3)
        k = x @ wk
        v = x @ wv
        scores = torch.einsum("bhqd,bkd->bhqk", q, k) * (Dh ** -0.5)
        p = _softmax(scores, axis=-1)
        o = torch.einsum("bhqk,bkd->bhqd", p, v)
        return (lambda x, *d: x.permute(*d))(o, 0, 2, 1, 3).reshape(B, S, H * Dh) @ wo

    def _B_ref(x, wqkv, wo):
        B, S, D = x.shape
        H = 32; Dh = D // H
        W, dil = 8, 2
        qkv = (lambda x, *d: x.permute(*d))((x @ wqkv).reshape(B, S, 3, H, Dh), 2, 0, 3, 1, 4)
        q, k, v = qkv[0], qkv[1], qkv[2]
        scale = Dh ** -0.5
        pos = torch.arange(S)
        off = torch.arange(W) * dil
        idx = pos[:, None] - off[None, :]
        mask = idx >= 0
        idx_c = torch.where(mask, idx, 0).reshape(-1)
        kg = k[:, :, idx_c, :].reshape(B, H, S, W, Dh)
        vg = v[:, :, idx_c, :].reshape(B, H, S, W, Dh)
        logits = torch.einsum("bhsd,bhswd->bhsw", q, kg) * scale
        logits = torch.where(mask[None, None, :, :], logits, -1e9)
        attn = _softmax(logits, axis=-1)
        o = torch.einsum("bhsw,bhswd->bhsd", attn, vg)
        return (lambda x, *d: x.permute(*d))(o, 0, 2, 1, 3).reshape(B, S, D) @ wo

    a = _A_ref(A_x, A_wq, A_wk, A_wv, A_wo)
    b = _B_ref(B_x, B_wqkv, B_wo)
    return torch.concatenate([a, b], axis=-1)
```

```asm
; @launch grid=(256,1,1) block=(768,1,1) lds=163840
.amdgcn_target "amdgcn-amd-amdhsa--gfx950"
.text
.globl concat_heads__grouped_kv_mqa__sliding_local_dilated__prompt_kernel
.p2align 8
.type concat_heads__grouped_kv_mqa__sliding_local_dilated__prompt_kernel,@function
concat_heads__grouped_kv_mqa__sliding_local_dilated__prompt_kernel:
    s_cmp_ge_u32 s2, 256
    s_cbranch_scc1 k_exit
    s_load_dwordx16 s[4:19], s[0:1], 0
    s_load_dwordx4 s[20:23], s[0:1], 64
    s_load_dwordx2 s[24:25], s[0:1], 80
    s_getpc_b64 s[32:33]
    v_lshlrev_b32 v3, 7, v0
    v_cmp_gt_u32 vcc, 144, v0
    s_nop 0
    s_and_saveexec_b64 s[34:35], vcc
    s_cbranch_execz k_nopf
    global_load_dword v167, v3, s[32:33]
k_nopf:
    s_mov_b64 exec, s[34:35]
    v_and_b32 v1, 63, v0
    v_lshrrev_b32 v2, 6, v0
    s_nop 0
    v_readfirstlane_b32 s26, v2
    s_and_b32 s27, s2, 7
    s_lshr_b32 s3, s2, 3
    s_lshl_b32 s40, s27, 3
    s_lshr_b32 s41, s3, 2
    s_add_u32 s40, s40, s41
    s_and_b32 s41, s3, 3
    s_lshl_b32 s27, s41, 1
    s_and_b32 s51, s40, 1
    s_add_u32 s27, s27, s51
    v_and_b32 v6, 31, v1
    v_lshrrev_b32 v7, 5, v1
    v_lshlrev_b32 v9, 4, v1
    v_mov_b32 v10, 163584
    v_mov_b32 v11, 1
    s_cmp_lt_u32 s26, 4
    s_cbranch_scc0 pre_a
    s_setprio 3
    s_and_b32 s45, s41, 1
    s_lshr_b32 s46, s41, 1
    s_mov_b32 s30, 16384
    s_mov_b32 s31, 0x20000
    s_lshl_b32 s51, s26, 12
    s_add_u32 m0, s51, 0
    v_mov_b32 v18, 258048
    s_cmp_eq_u32 s45, 0
    s_waitcnt lgkmcnt(0)
    s_cselect_b32 s28, s8, s10
    s_cselect_b32 s29, s9, s11
    buffer_load_dwordx4 v9, s[28:31], s51 offen offset:0 lds
    buffer_load_dwordx4 v9, s[28:31], s51 offen offset:1024 lds
    buffer_load_dwordx4 v9, s[28:31], s51 offen offset:2048 lds
    buffer_load_dwordx4 v9, s[28:31], s51 offen offset:3072 lds
    s_mov_b32 s36, s24
    s_mov_b32 s37, s25
    s_mov_b32 s38, 16777216
    s_mov_b32 s39, 0x20000
    buffer_load_dword v19, v18, s[36:39], 0 offen sc1
    s_barrier
    s_branch role_b
pre_a:
    s_sub_u32 s59, s26, 4
    s_and_b32 s42, s59, 3
    s_lshr_b32 s43, s59, 2
    s_lshr_b32 s46, s41, 1
    s_lshl_b32 s49, s46, 4
    s_lshl_b32 s48, s59, 1
    s_add_u32 s49, s49, s48
    s_xor_b32 s51, s49, 16
    s_lshl_b32 s52, s40, 5
    s_add_u32 s48, s52, s49
    s_lshl_b32 s48, s48, 10
    s_xor_b32 s50, s48, 16384
    s_mul_i32 s49, s49, 1040
    s_mul_i32 s51, s51, 1040
    s_mov_b32 s30, 0x200000
    s_mov_b32 s31, 0x20000
    s_add_u32 m0, s49, 16384
    s_waitcnt lgkmcnt(0)
    s_mov_b32 s28, s4
    s_mov_b32 s29, s5
    buffer_load_dwordx4 v9, s[28:31], s48 offen offset:0 lds
    s_add_u32 m0, s49, 16400
    s_nop 0
    buffer_load_dwordx4 v9, s[28:31], s48 offen offset:1024 lds
    s_add_u32 m0, s51, 16384
    s_nop 0
    buffer_load_dwordx4 v9, s[28:31], s50 offen offset:0 lds
    s_add_u32 m0, s51, 16400
    s_nop 0
    buffer_load_dwordx4 v9, s[28:31], s50 offen offset:1024 lds
    s_mov_b32 s36, s24
    s_mov_b32 s37, s25
    s_mov_b32 s38, 16777216
    s_mov_b32 s39, 0x20000
    s_barrier
    s_mov_b32 s32, s6
    s_mov_b32 s33, s7
    s_mov_b32 s34, 524288
    s_mov_b32 s35, 0x20000
    s_bfe_u32 s55, s3, 196610
    s_cmp_eq_u32 s43, 0
    s_cbranch_scc0 a_kh1
    v_mul_u32_u24 v4, 1040, v6
    v_lshl_add_u32 v4, v7, 4, v4
    v_lshlrev_b32 v8, 11, v7
    v_bfe_u32 v5, v1, 2, 2
    v_lshl_add_u32 v8, v5, 8, v8
    v_xor_b32 v5, s42, v5
    v_lshl_add_u32 v8, v5, 6, v8
    v_bfe_u32 v5, v1, 4, 1
    v_lshl_add_u32 v8, v5, 5, v8
    v_and_b32 v5, 3, v1
    v_lshl_add_u32 v8, v5, 3, v8
    s_waitcnt vmcnt(2) lgkmcnt(0)
    s_barrier
    s_waitcnt vmcnt(0)
    s_barrier
    s_add_u32 s51, s55, 0
    s_and_b32 s51, s51, 7
    s_lshl_b32 s51, s51, 7
    v_add_u32 v5, s51, v4
    ds_read_b128 v[16:19], v5 offset:16384
    ds_read_b128 v[20:23], v5 offset:16416
    ds_read_b128 v[24:27], v5 offset:16448
    ds_read_b128 v[28:31], v5 offset:16480
    s_add_u32 s51, s55, 1
    s_and_b32 s51, s51, 7
    s_lshl_b32 s51, s51, 7
    v_add_u32 v5, s51, v4
    ds_read_b128 v[32:35], v5 offset:16384
    ds_read_b128 v[36:39], v5 offset:16416
    ds_read_b128 v[40:43], v5 offset:16448
    ds_read_b128 v[44:47], v5 offset:16480
    s_add_u32 s51, s55, 2
    s_and_b32 s51, s51, 7
    s_lshl_b32 s51, s51, 7
    v_add_u32 v5, s51, v4
    ds_read_b128 v[48:51], v5 offset:16384
    ds_read_b128 v[52:55], v5 offset:16416
    ds_read_b128 v[56:59], v5 offset:16448
    ds_read_b128 v[60:63], v5 offset:16480
    s_add_u32 s51, s55, 3
    s_and_b32 s51, s51, 7
    s_lshl_b32 s51, s51, 7
    v_add_u32 v5, s51, v4
    ds_read_b128 v[64:67], v5 offset:16384
    ds_read_b128 v[68:71], v5 offset:16416
    ds_read_b128 v[72:75], v5 offset:16448
    ds_read_b128 v[76:79], v5 offset:16480
    s_add_u32 s51, s55, 4
    s_and_b32 s51, s51, 7
    s_lshl_b32 s51, s51, 7
    v_add_u32 v5, s51, v4
    ds_read_b128 v[80:83], v5 offset:16384
    ds_read_b128 v[84:87], v5 offset:16416
    ds_read_b128 v[88:91], v5 offset:16448
    ds_read_b128 v[92:95], v5 offset:16480
    s_add_u32 s51, s55, 5
    s_and_b32 s51, s51, 7
    s_lshl_b32 s51, s51, 7
    v_add_u32 v5, s51, v4
    ds_read_b128 v[96:99], v5 offset:16384
    ds_read_b128 v[100:103], v5 offset:16416
    ds_read_b128 v[104:107], v5 offset:16448
    ds_read_b128 v[108:111], v5 offset:16480
    s_add_u32 s51, s55, 6
    s_and_b32 s51, s51, 7
    s_lshl_b32 s51, s51, 7
    v_add_u32 v5, s51, v4
    ds_read_b128 v[112:115], v5 offset:16384
    ds_read_b128 v[116:119], v5 offset:16416
    ds_read_b128 v[120:123], v5 offset:16448
    ds_read_b128 v[124:127], v5 offset:16480
    s_add_u32 s51, s55, 7
    s_and_b32 s51, s51, 7
    s_lshl_b32 s51, s51, 7
    v_add_u32 v5, s51, v4
    ds_read_b128 v[128:131], v5 offset:16384
    ds_read_b128 v[132:135], v5 offset:16416
    ds_read_b128 v[136:139], v5 offset:16448
    ds_read_b128 v[140:143], v5 offset:16480
    v_add_u32 v5, 16384, v8
    v_add_u32 v15, 115200, v8
    v_add_u32 v8, 66048, v8
    s_waitcnt lgkmcnt(0)
    s_barrier
    ds_read_b64_tr_b16 v[144:145], v5 offset:33280
    ds_read_b64_tr_b16 v[146:147], v5 offset:34304
    ds_read_b64_tr_b16 v[148:149], v5 offset:37376
    ds_read_b64_tr_b16 v[150:151], v5 offset:38400
    s_waitcnt lgkmcnt(2)
    v_mfma_f32_32x32x16_bf16 v[152:167], v[144:147], v[16:19], 0
    ds_read_b64_tr_b16 v[144:145], v5 offset:41472
    ds_read_b64_tr_b16 v[146:147], v5 offset:42496
    ds_read_b64_tr_b16 v[16:17], v5 offset:45568
    ds_read_b64_tr_b16 v[18:19], v5 offset:46592
    s_waitcnt lgkmcnt(4)
    v_mfma_f32_32x32x16_bf16 v[152:167], v[148:151], v[20:23], v[152:167]
    ds_read_b64_tr_b16 v[148:149], v8 offset:0
    ds_read_b64_tr_b16 v[150:151], v8 offset:1024
    ds_read_b64_tr_b16 v[20:21], v8 offset:4096
    ds_read_b64_tr_b16 v[22:23], v8 offset:5120
    s_waitcnt lgkmcnt(6)
    v_mfma_f32_32x32x16_bf16 v[152:167], v[144:147], v[24:27], v[152:167]
    ds_read_b64_tr_b16 v[144:145], v8 offset:8192
    ds_read_b64_tr_b16 v[146:147], v8 offset:9216
    ds_read_b64_tr_b16 v[24:25], v8 offset:12288
    ds_read_b64_tr_b16 v[26:27], v8 offset:13312
    s_waitcnt lgkmcnt(8)
    v_mfma_f32_32x32x16_bf16 v[152:167], v[16:19], v[28:31], v[152:167]
    s_barrier
    ds_read_b64_tr_b16 v[16:17], v8 offset:16384
    ds_read_b64_tr_b16 v[18:19], v8 offset:17408
    ds_read_b64_tr_b16 v[28:29], v8 offset:20480
    ds_read_b64_tr_b16 v[30:31], v8 offset:21504
    s_waitcnt lgkmcnt(10)
    v_mfma_f32_32x32x16_bf16 v[152:167], v[148:151], v[32:35], v[152:167]
    ds_read_b64_tr_b16 v[148:149], v8 offset:24576
    ds_read_b64_tr_b16 v[150:151], v8 offset:25600
    ds_read_b64_tr_b16 v[32:33], v8 offset:28672
    ds_read_b64_tr_b16 v[34:35], v8 offset:29696
    s_waitcnt lgkmcnt(12)
    v_mfma_f32_32x32x16_bf16 v[152:167], v[20:23], v[36:39], v[152:167]
    ds_read_b64_tr_b16 v[20:21], v8 offset:32768
    ds_read_b64_tr_b16 v[22:23], v8 offset:33792
    s_waitcnt lgkmcnt(12)
    v_mfma_f32_32x32x16_bf16 v[152:167], v[144:147], v[40:43], v[152:167]
    ds_read_b64_tr_b16 v[36:37], v8 offset:36864
    ds_read_b64_tr_b16 v[38:39], v8 offset:37888
    s_waitcnt lgkmcnt(12)
    v_mfma_f32_32x32x16_bf16 v[152:167], v[24:27], v[44:47], v[152:167]
    ds_read_b64_tr_b16 v[40:41], v8 offset:40960
    ds_read_b64_tr_b16 v[42:43], v8 offset:41984
    s_waitcnt lgkmcnt(12)
    v_mfma_f32_32x32x16_bf16 v[152:167], v[16:19], v[48:51], v[152:167]
    ds_read_b64_tr_b16 v[24:25], v8 offset:45056
    ds_read_b64_tr_b16 v[26:27], v8 offset:46080
    s_waitcnt lgkmcnt(12)
    v_mfma_f32_32x32x16_bf16 v[152:167], v[28:31], v[52:55], v[152:167]
    s_waitcnt lgkmcnt(10)
    v_mfma_f32_32x32x16_bf16 v[152:167], v[148:151], v[56:59], v[152:167]
    s_waitcnt lgkmcnt(8)
    v_mfma_f32_32x32x16_bf16 v[152:167], v[32:35], v[60:63], v[152:167]
    s_barrier
    ds_read_b64_tr_b16 v[44:45], v15 offset:0
    ds_read_b64_tr_b16 v[46:47], v15 offset:1024
    ds_read_b64_tr_b16 v[16:17], v15 offset:4096
    ds_read_b64_tr_b16 v[18:19], v15 offset:5120
    ds_read_b64_tr_b16 v[28:29], v15 offset:8192
    ds_read_b64_tr_b16 v[30:31], v15 offset:9216
    s_waitcnt lgkmcnt(12)
    v_mfma_f32_32x32x16_bf16 v[152:167], v[20:23], v[64:67], v[152:167]
    ds_read_b64_tr_b16 v[32:33], v15 offset:12288
    ds_read_b64_tr_b16 v[34:35], v15 offset:13312
    s_waitcnt lgkmcnt(12)
    v_mfma_f32_32x32x16_bf16 v[152:167], v[36:39], v[68:71], v[152:167]
    ds_read_b64_tr_b16 v[20:21], v15 offset:16384
    ds_read_b64_tr_b16 v[22:23], v15 offset:17408
    s_waitcnt lgkmcnt(12)
    v_mfma_f32_32x32x16_bf16 v[152:167], v[40:43], v[72:75], v[152:167]
    ds_read_b64_tr_b16 v[36:37], v15 offset:20480
    ds_read_b64_tr_b16 v[38:39], v15 offset:21504
    s_waitcnt lgkmcnt(12)
    v_mfma_f32_32x32x16_bf16 v[152:167], v[24:27], v[76:79], v[152:167]
    ds_read_b64_tr_b16 v[40:41], v15 offset:24576
    ds_read_b64_tr_b16 v[42:43], v15 offset:25600
    s_waitcnt lgkmcnt(12)
    v_mfma_f32_32x32x16_bf16 v[152:167], v[44:47], v[80:83], v[152:167]
    ds_read_b64_tr_b16 v[24:25], v15 offset:28672
    ds_read_b64_tr_b16 v[26:27], v15 offset:29696
    s_waitcnt lgkmcnt(12)
    v_mfma_f32_32x32x16_bf16 v[152:167], v[16:19], v[84:87], v[152:167]
    v_mov_b32 v48, 0
    v_mov_b32 v49, 0
    v_mov_b32 v50, 0
    v_mov_b32 v51, 0
    v_mov_b32 v52, 0
    v_mov_b32 v53, 0
    v_mov_b32 v54, 0
    v_mov_b32 v55, 0
    v_mov_b32 v56, 0
    v_mov_b32 v57, 0
    v_mov_b32 v58, 0
    v_mov_b32 v59, 0
    v_mov_b32 v60, 0
    v_mov_b32 v61, 0
    v_mov_b32 v62, 0
    v_mov_b32 v63, 0
    v_mov_b32 v64, 0
    v_mov_b32 v65, 0
    v_mov_b32 v66, 0
    v_mov_b32 v67, 0
    v_mov_b32 v68, 0
    v_mov_b32 v69, 0
    v_mov_b32 v70, 0
    v_mov_b32 v71, 0
    v_mov_b32 v72, 0
    v_mov_b32 v73, 0
    v_mov_b32 v74, 0
    v_mov_b32 v75, 0
    v_mov_b32 v76, 0
    v_mov_b32 v77, 0
    v_mov_b32 v78, 0
    v_mov_b32 v79, 0
    s_lshl_b32 s56, s43, 11
    v_add_u32 v2, s56, v9
    v_lshlrev_b32 v3, 8, v7
    v_lshl_add_u32 v3, v6, 4, v3
    v_add_u32 v3, s56, v3
    s_mov_b32 s60, 0x0000ffff
    s_mov_b32 s61, 0x0000ffff
    v_and_b32 v14, 27, v6
    v_cmp_eq_u32 vcc, 16, v14
    v_mov_b32 v13, 0x53805380
    s_nop 0
    v_cndmask_b32 v14, 0, v13, vcc
    v_mov_b32 v144, v14
    v_mov_b32 v145, v14
    v_mov_b32 v146, v14
    v_mov_b32 v147, v14
    v_mov_b32 v148, v14
    v_mov_b32 v149, v14
    v_mov_b32 v150, v14
    v_mov_b32 v151, v14
    s_waitcnt lgkmcnt(10)
    v_mfma_f32_32x32x16_bf16 v[152:167], v[28:31], v[88:91], v[152:167]
    s_waitcnt lgkmcnt(8)
    v_mfma_f32_32x32x16_bf16 v[152:167], v[32:35], v[92:95], v[152:167]
    s_barrier
    ds_read_b64_tr_b16 v[44:45], v5 offset:0
    ds_read_b64_tr_b16 v[46:47], v5 offset:1024
    ds_read_b64_tr_b16 v[80:81], v5 offset:4096
    ds_read_b64_tr_b16 v[82:83], v5 offset:5120
    ds_read_b64_tr_b16 v[16:17], v5 offset:8192
    ds_read_b64_tr_b16 v[18:19], v5 offset:9216
    s_waitcnt lgkmcnt(12)
    v_mfma_f32_32x32x16_bf16 v[152:167], v[20:23], v[96:99], v[152:167]
    ds_read_b64_tr_b16 v[84:85], v5 offset:12288
    ds_read_b64_tr_b16 v[86:87], v5 offset:13312
    s_waitcnt lgkmcnt(12)
    v_mfma_f32_32x32x16_bf16 v[152:167], v[36:39], v[100:103], v[152:167]
    ds_read_b64_tr_b16 v[28:29], v5 offset:16384
    ds_read_b64_tr_b16 v[30:31], v5 offset:17408
    s_waitcnt lgkmcnt(12)
    v_mfma_f32_32x32x16_bf16 v[152:167], v[40:43], v[104:107], v[152:167]
    ds_read_b64_tr_b16 v[88:89], v5 offset:20480
    ds_read_b64_tr_b16 v[90:91], v5 offset:21504
    s_waitcnt lgkmcnt(12)
    v_mfma_f32_32x32x16_bf16 v[152:167], v[24:27], v[108:111], v[152:167]
    ds_read_b64_tr_b16 v[32:33], v5 offset:24576
    ds_read_b64_tr_b16 v[34:35], v5 offset:25600
    s_waitcnt lgkmcnt(12)
    v_mfma_f32_32x32x16_bf16 v[152:167], v[44:47], v[112:115], v[152:167]
    ds_read_b64_tr_b16 v[92:93], v5 offset:28672
    ds_read_b64_tr_b16 v[94:95], v5 offset:29696
    s_mov_b64 exec, 1
    ds_add_u32 v10, v11 offset:96
    s_mov_b64 exec, -1
    s_waitcnt lgkmcnt(13)
    v_mfma_f32_32x32x16_bf16 v[152:167], v[80:83], v[116:119], v[152:167]
    s_waitcnt lgkmcnt(11)
    v_mfma_f32_32x32x16_bf16 v[152:167], v[16:19], v[120:123], v[152:167]
    s_waitcnt lgkmcnt(9)
    v_mfma_f32_32x32x16_bf16 v[152:167], v[84:87], v[124:127], v[152:167]
    s_waitcnt lgkmcnt(7)
    v_mfma_f32_32x32x16_bf16 v[152:167], v[28:31], v[128:131], v[152:167]
    s_waitcnt lgkmcnt(5)
    v_mfma_f32_32x32x16_bf16 v[152:167], v[88:91], v[132:135], v[152:167]
    s_waitcnt lgkmcnt(3)
    v_mfma_f32_32x32x16_bf16 v[152:167], v[32:35], v[136:139], v[152:167]
    s_waitcnt lgkmcnt(1)
    v_mfma_f32_32x32x16_bf16 v[152:167], v[92:95], v[140:143], v[152:167]
    s_mov_b32 s51, 1052289595
    s_lshl_b32 s53, s42, 11
    s_add_u32 s53, s53, 155392
    v_add_u32 v12, s53, v9
    s_lshl_b32 s53, s42, 2
    v_add_u32 v13, s53, v10
    s_nop 5
    v_mul_f32 v152, s51, v152
    v_mul_f32 v153, s51, v153
    v_mul_f32 v154, s51, v154
    v_mul_f32 v155, s51, v155
    v_mul_f32 v156, s51, v156
    v_mul_f32 v157, s51, v157
    v_mul_f32 v158, s51, v158
    v_mul_f32 v159, s51, v159
    v_mul_f32 v160, s51, v160
    v_mul_f32 v161, s51, v161
    v_mul_f32 v162, s51, v162
    v_mul_f32 v163, s51, v163
    v_mul_f32 v164, s51, v164
    v_mul_f32 v165, s51, v165
    v_mul_f32 v166, s51, v166
    v_mul_f32 v167, s51, v167
    v_cvt_pk_bf16_f32 v132, v152, v153
    v_cvt_pk_bf16_f32 v133, v154, v155
    v_cvt_pk_bf16_f32 v134, v156, v157
    v_cvt_pk_bf16_f32 v135, v158, v159
    v_cvt_pk_bf16_f32 v128, v160, v161
    v_cvt_pk_bf16_f32 v129, v162, v163
    v_cvt_pk_bf16_f32 v130, v164, v165
    v_cvt_pk_bf16_f32 v131, v166, v167
    ds_write_b128 v12, v[132:135]
    ds_write_b128 v12, v[128:131] offset:1024
    s_mov_b64 exec, 1
    ds_add_u32 v13, v11 offset:40
    s_mov_b64 exec, -1
    s_branch a_join
a_kh1:
    v_lshrrev_b32 v4, 4, v1
    v_bfe_u32 v5, v1, 2, 2
    v_xor_b32 v5, v5, v4
    v_lshlrev_b32 v3, 10, v4
    v_lshl_add_u32 v3, v5, 6, v3
    v_and_b32 v5, 3, v1
    v_lshl_add_u32 v3, v5, 4, v3
    s_lshl_b32 s48, s42, 14
    s_lshl_b32 s51, s41, 8
    s_add_u32 s48, s48, s51
    s_lshl_b32 s49, s42, 12
    s_add_u32 s51, s55, 0
    s_and_b32 s51, s51, 7
    s_lshl_b32 s51, s51, 16
    s_add_u32 s51, s51, s48
    s_add_u32 m0, s49, 49664
    s_nop 0
    buffer_load_dwordx4 v3, s[32:35], s51 offen lds
    s_add_u32 m0, s49, 50688
    s_add_u32 s51, s51, 4096
    buffer_load_dwordx4 v3, s[32:35], s51 offen lds
    s_add_u32 m0, s49, 51712
    s_add_u32 s51, s51, 4096
    buffer_load_dwordx4 v3, s[32:35], s51 offen lds
    s_add_u32 m0, s49, 52736
    s_add_u32 s51, s51, 4096
    buffer_load_dwordx4 v3, s[32:35], s51 offen lds
    s_add_u32 s51, s55, 1
    s_and_b32 s51, s51, 7
    s_lshl_b32 s51, s51, 16
    s_add_u32 s51, s51, s48
    s_add_u32 m0, s49, 66048
    s_nop 0
    buffer_load_dwordx4 v3, s[32:35], s51 offen lds
    s_add_u32 m0, s49, 67072
    s_add_u32 s51, s51, 4096
    buffer_load_dwordx4 v3, s[32:35], s51 offen lds
    s_add_u32 m0, s49, 68096
    s_add_u32 s51, s51, 4096
    buffer_load_dwordx4 v3, s[32:35], s51 offen lds
    s_add_u32 m0, s49, 69120
    s_add_u32 s51, s51, 4096
    buffer_load_dwordx4 v3, s[32:35], s51 offen lds
    s_waitcnt vmcnt(10) lgkmcnt(0)
    s_barrier
    s_waitcnt vmcnt(8)
    s_barrier
    s_add_u32 s51, s55, 2
    s_and_b32 s51, s51, 7
    s_lshl_b32 s51, s51, 16
    s_add_u32 s51, s51, s48
    s_add_u32 m0, s49, 82432
    s_nop 0
    buffer_load_dwordx4 v3, s[32:35], s51 offen lds
    s_add_u32 m0, s49, 83456
    s_add_u32 s51, s51, 4096
    buffer_load_dwordx4 v3, s[32:35], s51 offen lds
    s_add_u32 m0, s49, 84480
    s_add_u32 s51, s51, 4096
    buffer_load_dwordx4 v3, s[32:35], s51 offen lds
    s_add_u32 m0, s49, 85504
    s_add_u32 s51, s51, 4096
    buffer_load_dwordx4 v3, s[32:35], s51 offen lds
    s_add_u32 s51, s55, 3
    s_and_b32 s51, s51, 7
    s_lshl_b32 s51, s51, 16
    s_add_u32 s51, s51, s48
    s_add_u32 m0, s49, 98816
    s_nop 0
    buffer_load_dwordx4 v3, s[32:35], s51 offen lds
    s_add_u32 m0, s49, 99840
    s_add_u32 s51, s51, 4096
    buffer_load_dwordx4 v3, s[32:35], s51 offen lds
    s_add_u32 m0, s49, 100864
    s_add_u32 s51, s51, 4096
    buffer_load_dwordx4 v3, s[32:35], s51 offen lds
    s_add_u32 m0, s49, 101888
    s_add_u32 s51, s51, 4096
    buffer_load_dwordx4 v3, s[32:35], s51 offen lds
    s_waitcnt vmcnt(8)
    s_barrier
    s_add_u32 s51, s55, 4
    s_and_b32 s51, s51, 7
    s_lshl_b32 s51, s51, 16
    s_add_u32 s51, s51, s48
    s_add_u32 m0, s49, 115200
    s_nop 0
    buffer_load_dwordx4 v3, s[32:35], s51 offen lds
    s_add_u32 m0, s49, 116224
    s_add_u32 s51, s51, 4096
    buffer_load_dwordx4 v3, s[32:35], s51 offen lds
    s_add_u32 m0, s49, 117248
    s_add_u32 s51, s51, 4096
    buffer_load_dwordx4 v3, s[32:35], s51 offen lds
    s_add_u32 m0, s49, 118272
    s_add_u32 s51, s51, 4096
    buffer_load_dwordx4 v3, s[32:35], s51 offen lds
    s_add_u32 s51, s55, 5
    s_and_b32 s51, s51, 7
    s_lshl_b32 s51, s51, 16
    s_add_u32 s51, s51, s48
    s_add_u32 m0, s49, 131584
    s_nop 0
    buffer_load_dwordx4 v3, s[32:35], s51 offen lds
    s_add_u32 m0, s49, 132608
    s_add_u32 s51, s51, 4096
    buffer_load_dwordx4 v3, s[32:35], s51 offen lds
    s_add_u32 m0, s49, 133632
    s_add_u32 s51, s51, 4096
    buffer_load_dwordx4 v3, s[32:35], s51 offen lds
    s_add_u32 m0, s49, 134656
    s_add_u32 s51, s51, 4096
    buffer_load_dwordx4 v3, s[32:35], s51 offen lds
    s_waitcnt vmcnt(8)
    s_barrier
    s_add_u32 s51, s55, 6
    s_and_b32 s51, s51, 7
    s_lshl_b32 s51, s51, 16
    s_add_u32 s51, s51, s48
    s_add_u32 m0, s49, 16384
    s_nop 0
    buffer_load_dwordx4 v3, s[32:35], s51 offen lds
    s_add_u32 m0, s49, 17408
    s_add_u32 s51, s51, 4096
    buffer_load_dwordx4 v3, s[32:35], s51 offen lds
    s_add_u32 m0, s49, 18432
    s_add_u32 s51, s51, 4096
    buffer_load_dwordx4 v3, s[32:35], s51 offen lds
    s_add_u32 m0, s49, 19456
    s_add_u32 s51, s51, 4096
    buffer_load_dwordx4 v3, s[32:35], s51 offen lds
    s_add_u32 s51, s55, 7
    s_and_b32 s51, s51, 7
    s_lshl_b32 s51, s51, 16
    s_add_u32 s51, s51, s48
    s_add_u32 m0, s49, 32768
    s_nop 0
    buffer_load_dwordx4 v3, s[32:35], s51 offen lds
    s_add_u32 m0, s49, 33792
    s_add_u32 s51, s51, 4096
    buffer_load_dwordx4 v3, s[32:35], s51 offen lds
    s_add_u32 m0, s49, 34816
    s_add_u32 s51, s51, 4096
    buffer_load_dwordx4 v3, s[32:35], s51 offen lds
    s_add_u32 m0, s49, 35840
    s_add_u32 s51, s51, 4096
    buffer_load_dwordx4 v3, s[32:35], s51 offen lds
    s_waitcnt vmcnt(8)
    s_barrier
    s_waitcnt vmcnt(0)
    s_barrier
    v_mov_b32 v48, 0
    v_mov_b32 v49, 0
    v_mov_b32 v50, 0
    v_mov_b32 v51, 0
    v_mov_b32 v52, 0
    v_mov_b32 v53, 0
    v_mov_b32 v54, 0
    v_mov_b32 v55, 0
    v_mov_b32 v56, 0
    v_mov_b32 v57, 0
    v_mov_b32 v58, 0
    v_mov_b32 v59, 0
    v_mov_b32 v60, 0
    v_mov_b32 v61, 0
    v_mov_b32 v62, 0
    v_mov_b32 v63, 0
    v_mov_b32 v64, 0
    v_mov_b32 v65, 0
    v_mov_b32 v66, 0
    v_mov_b32 v67, 0
    v_mov_b32 v68, 0
    v_mov_b32 v69, 0
    v_mov_b32 v70, 0
    v_mov_b32 v71, 0
    v_mov_b32 v72, 0
    v_mov_b32 v73, 0
    v_mov_b32 v74, 0
    v_mov_b32 v75, 0
    v_mov_b32 v76, 0
    v_mov_b32 v77, 0
    v_mov_b32 v78, 0
    v_mov_b32 v79, 0
    s_lshl_b32 s56, s43, 11
    v_add_u32 v2, s56, v9
    v_lshlrev_b32 v3, 8, v7
    v_lshl_add_u32 v3, v6, 4, v3
    v_add_u32 v3, s56, v3
    s_mov_b32 s60, 0x0000ffff
    s_mov_b32 s61, 0x0000ffff
    v_and_b32 v14, 27, v6
    v_cmp_eq_u32 vcc, 16, v14
    v_mov_b32 v13, 0x53805380
    s_nop 0
    v_cndmask_b32 v14, 0, v13, vcc
    v_mov_b32 v144, v14
    v_mov_b32 v145, v14
    v_mov_b32 v146, v14
    v_mov_b32 v147, v14
    v_mov_b32 v148, v14
    v_mov_b32 v149, v14
    v_mov_b32 v150, v14
    v_mov_b32 v151, v14
    s_lshl_b32 s53, s42, 11
    s_add_u32 s53, s53, 155392
    v_add_u32 v15, s53, v9
    s_lshl_b32 s53, s42, 2
    v_add_u32 v13, s53, v10
lw_1:
    ds_read_b32 v12, v13 offset:40
    s_waitcnt lgkmcnt(0)
    v_readfirstlane_b32 s51, v12
    s_nop 0
    s_cmp_ge_u32 s51, 1
    s_cbranch_scc1 lwd_2
    s_sleep 1
    s_branch lw_1
lwd_2:
    ds_read_b128 v[128:131], v15
    ds_read_b128 v[132:135], v15 offset:1024
    s_mov_b64 exec, 1
    ds_add_u32 v10, v11 offset:12
    s_mov_b64 exec, -1
a_join:
    v_mov_b32 v152, v14
    v_mov_b32 v153, v14
    v_mov_b32 v154, v14
    v_mov_b32 v155, v14
    v_mov_b32 v156, v14
    v_mov_b32 v157, v14
    v_mov_b32 v158, v14
    v_mov_b32 v159, v14
    v_mov_b32 v124, 0
    v_mov_b32 v125, 0
    v_mov_b32 v126, 0
    v_mov_b32 v127, 0
lw_3:
    ds_read_b32 v12, v10 offset:16
    s_waitcnt lgkmcnt(0)
    v_readfirstlane_b32 s51, v12
    s_nop 0
    s_cmp_ge_u32 s51, 4
    s_cbranch_scc1 lwd_4
    s_branch lw_3
lwd_4:
    ds_read_b128 v[112:115], v9
    ds_read_b128 v[136:139], v2 offset:0
    s_mov_b64 exec, s[60:61]
    ds_read_b128 v[144:147], v3 offset:1024
    ds_read_b128 v[148:151], v3 offset:1536
    s_mov_b64 exec, -1
    ds_read_b128 v[140:143], v2 offset:4096
    s_waitcnt lgkmcnt(4)
    v_mfma_f32_32x32x16_bf16 v[16:31], v[112:115], v[128:131], 0
    v_mfma_f32_32x32x16_bf16 v[32:47], v[112:115], v[132:135], 0
    s_nop 10
    v_max3_f32 v12, v16, v17, v18
    v_max3_f32 v12, v12, v19, v20
    v_max3_f32 v12, v12, v21, v22
    v_max3_f32 v12, v12, v23, v24
    v_max3_f32 v12, v12, v25, v26
    v_max3_f32 v12, v12, v27, v28
    v_max3_f32 v12, v12, v29, v30
    v_max_f32 v12, v12, v31
    v_mov_b32 v13, v12
    s_nop 1
    v_permlane32_swap_b32 v12, v13
    v_max_f32 v12, v12, v13
    v_sub_f32 v80, 0xc2c80000, v12
    v_mov_b32 v81, v80
    v_mov_b32 v82, v80
    v_mov_b32 v83, v80
    v_mov_b32 v84, v80
    v_mov_b32 v85, v80
    v_mov_b32 v86, v80
    v_mov_b32 v87, v80
    v_mov_b32 v88, v80
    v_mov_b32 v89, v80
    v_mov_b32 v90, v80
    v_mov_b32 v91, v80
    v_mov_b32 v92, v80
    v_mov_b32 v93, v80
    v_mov_b32 v94, v80
    v_mov_b32 v95, v80
    s_waitcnt lgkmcnt(0)
    s_nop 0
    v_mfma_f32_32x32x16_bf16 v[16:31], v[136:139], v[128:131], v[80:95]
    v_max3_f32 v12, v32, v33, v34
    v_max3_f32 v12, v12, v35, v36
    v_max3_f32 v12, v12, v37, v38
    v_max3_f32 v12, v12, v39, v40
    v_max3_f32 v12, v12, v41, v42
    v_max3_f32 v12, v12, v43, v44
    v_max3_f32 v12, v12, v45, v46
    v_max_f32 v12, v12, v47
    v_mov_b32 v13, v12
    s_nop 1
    v_permlane32_swap_b32 v12, v13
    v_max_f32 v12, v12, v13
    v_sub_f32 v96, 0xc2c80000, v12
    v_mov_b32 v97, v96
    v_mov_b32 v98, v96
    v_mov_b32 v99, v96
    v_mov_b32 v100, v96
    v_mov_b32 v101, v96
    v_mov_b32 v102, v96
    v_mov_b32 v103, v96
    v_mov_b32 v104, v96
    v_mov_b32 v105, v96
    v_mov_b32 v106, v96
    v_mov_b32 v107, v96
    v_mov_b32 v108, v96
    v_mov_b32 v109, v96
    v_mov_b32 v110, v96
    v_mov_b32 v111, v96
    s_mov_b32 s50, 0
    s_setprio 3
.p2align 6
a_loop:
    v_exp_f32 v16, v16
    v_exp_f32 v17, v17
    v_mfma_f32_32x32x16_bf16 v[64:79], v[156:159], v[124:127], v[64:79]
    s_mov_b64 exec, s[60:61]
    ds_read_b128 v[152:155], v3 offset:5120
    ds_read_b128 v[156:159], v3 offset:5632
    s_mov_b64 exec, -1
    v_exp_f32 v18, v18
    v_exp_f32 v19, v19
    v_exp_f32 v20, v20
    v_exp_f32 v21, v21
    v_exp_f32 v22, v22
    v_exp_f32 v23, v23
    v_mfma_f32_32x32x16_bf16 v[32:47], v[136:139], v[132:135], v[96:111]
    ds_read_b128 v[136:139], v2 offset:8192
    v_cvt_pk_bf16_f32 v112, v16, v17
    v_cvt_pk_bf16_f32 v113, v18, v19
    v_cvt_pk_bf16_f32 v114, v20, v21
    v_cvt_pk_bf16_f32 v115, v22, v23
    v_exp_f32 v24, v24
    v_exp_f32 v25, v25
    v_exp_f32 v26, v26
    v_exp_f32 v27, v27
    s_waitcnt lgkmcnt(3)
    v_mfma_f32_32x32x16_bf16 v[48:63], v[144:147], v[112:115], v[48:63]
    v_exp_f32 v28, v28
    v_exp_f32 v29, v29
    v_exp_f32 v30, v30
    v_exp_f32 v31, v31
    v_cvt_pk_bf16_f32 v116, v24, v25
    v_cvt_pk_bf16_f32 v117, v26, v27
    v_cvt_pk_bf16_f32 v118, v28, v29
    v_cvt_pk_bf16_f32 v119, v30, v31
    v_exp_f32 v32, v32
    v_exp_f32 v33, v33
    v_mfma_f32_32x32x16_bf16 v[48:63], v[148:151], v[116:119], v[48:63]
    v_exp_f32 v34, v34
    v_exp_f32 v35, v35
    v_exp_f32 v36, v36
    v_exp_f32 v37, v37
    v_exp_f32 v38, v38
    v_exp_f32 v39, v39
    v_mfma_f32_32x32x16_bf16 v[16:31], v[140:143], v[128:131], v[80:95]
    v_cvt_pk_bf16_f32 v120, v32, v33
    v_cvt_pk_bf16_f32 v121, v34, v35
    v_cvt_pk_bf16_f32 v122, v36, v37
    v_cvt_pk_bf16_f32 v123, v38, v39
    v_exp_f32 v40, v40
    v_exp_f32 v41, v41
    v_exp_f32 v42, v42
    v_exp_f32 v43, v43
    v_mfma_f32_32x32x16_bf16 v[64:79], v[144:147], v[120:123], v[64:79]
    v_exp_f32 v44, v44
    v_exp_f32 v45, v45
    v_exp_f32 v46, v46
    v_exp_f32 v47, v47
    v_cvt_pk_bf16_f32 v124, v40, v41
    v_cvt_pk_bf16_f32 v125, v42, v43
    v_cvt_pk_bf16_f32 v126, v44, v45
    v_cvt_pk_bf16_f32 v127, v46, v47
    v_exp_f32 v16, v16
    v_exp_f32 v17, v17
    v_mfma_f32_32x32x16_bf16 v[64:79], v[148:151], v[124:127], v[64:79]
    s_mov_b64 exec, s[60:61]
    ds_read_b128 v[144:147], v3 offset:9216
    ds_read_b128 v[148:151], v3 offset:9728
    s_mov_b64 exec, -1
    v_exp_f32 v18, v18
    v_exp_f32 v19, v19
    v_exp_f32 v20, v20
    v_exp_f32 v21, v21
    v_exp_f32 v22, v22
    v_exp_f32 v23, v23
    v_mfma_f32_32x32x16_bf16 v[32:47], v[140:143], v[132:135], v[96:111]
    ds_read_b128 v[140:143], v2 offset:12288
    v_cvt_pk_bf16_f32 v112, v16, v17
    v_cvt_pk_bf16_f32 v113, v18, v19
    v_cvt_pk_bf16_f32 v114, v20, v21
    v_cvt_pk_bf16_f32 v115, v22, v23
    v_exp_f32 v24, v24
    v_exp_f32 v25, v25
    v_exp_f32 v26, v26
    v_exp_f32 v27, v27
    s_waitcnt lgkmcnt(3)
    v_mfma_f32_32x32x16_bf16 v[48:63], v[152:155], v[112:115], v[48:63]
    v_exp_f32 v28, v28
    v_exp_f32 v29, v29
    v_exp_f32 v30, v30
    v_exp_f32 v31, v31
    v_cvt_pk_bf16_f32 v116, v24, v25
    v_cvt_pk_bf16_f32 v117, v26, v27
    v_cvt_pk_bf16_f32 v118, v28, v29
    v_cvt_pk_bf16_f32 v119, v30, v31
    v_exp_f32 v32, v32
    v_exp_f32 v33, v33
    v_mfma_f32_32x32x16_bf16 v[48:63], v[156:159], v[116:119], v[48:63]
    v_exp_f32 v34, v34
    v_exp_f32 v35, v35
    v_exp_f32 v36, v36
    v_exp_f32 v37, v37
    v_exp_f32 v38, v38
    v_exp_f32 v39, v39
    v_mfma_f32_32x32x16_bf16 v[16:31], v[136:139], v[128:131], v[80:95]
    v_cvt_pk_bf16_f32 v120, v32, v33
    v_cvt_pk_bf16_f32 v121, v34, v35
    v_cvt_pk_bf16_f32 v122, v36, v37
    v_cvt_pk_bf16_f32 v123, v38, v39
    v_exp_f32 v40, v40
    v_exp_f32 v41, v41
    v_exp_f32 v42, v42
    v_exp_f32 v43, v43
    v_mfma_f32_32x32x16_bf16 v[64:79], v[152:155], v[120:123], v[64:79]
    v_exp_f32 v44, v44
    v_exp_f32 v45, v45
    v_exp_f32 v46, v46
    v_exp_f32 v47, v47
    v_cvt_pk_bf16_f32 v124, v40, v41
    v_cvt_pk_bf16_f32 v125, v42, v43
    v_cvt_pk_bf16_f32 v126, v44, v45
    v_cvt_pk_bf16_f32 v127, v46, v47
    v_exp_f32 v16, v16
    v_exp_f32 v17, v17
    v_mfma_f32_32x32x16_bf16 v[64:79], v[156:159], v[124:127], v[64:79]
    s_bitcmp1_b32 s50, 2
    s_cbranch_scc1 a_hk_hi
    s_branch a_hk_lo
a_hk_done:
    s_mov_b64 exec, s[60:61]
    ds_read_b128 v[152:155], v3 offset:13312
    ds_read_b128 v[156:159], v3 offset:13824
    s_mov_b64 exec, -1
    v_exp_f32 v18, v18
    v_exp_f32 v19, v19
    v_exp_f32 v20, v20
    v_exp_f32 v21, v21
    v_exp_f32 v22, v22
    v_exp_f32 v23, v23
    v_mfma_f32_32x32x16_bf16 v[32:47], v[136:139], v[132:135], v[96:111]
    ds_read_b128 v[136:139], v2 offset:16384
    v_cvt_pk_bf16_f32 v112, v16, v17
    v_cvt_pk_bf16_f32 v113, v18, v19
    v_cvt_pk_bf16_f32 v114, v20, v21
    v_cvt_pk_bf16_f32 v115, v22, v23
    v_exp_f32 v24, v24
    v_exp_f32 v25, v25
    v_exp_f32 v26, v26
    v_exp_f32 v27, v27
    s_waitcnt lgkmcnt(3)
    v_mfma_f32_32x32x16_bf16 v[48:63], v[144:147], v[112:115], v[48:63]
    v_exp_f32 v28, v28
    v_exp_f32 v29, v29
    v_exp_f32 v30, v30
    v_exp_f32 v31, v31
    v_cvt_pk_bf16_f32 v116, v24, v25
    v_cvt_pk_bf16_f32 v117, v26, v27
    v_cvt_pk_bf16_f32 v118, v28, v29
    v_cvt_pk_bf16_f32 v119, v30, v31
    v_exp_f32 v32, v32
    v_exp_f32 v33, v33
    v_mfma_f32_32x32x16_bf16 v[48:63], v[148:151], v[116:119], v[48:63]
    v_exp_f32 v34, v34
    v_exp_f32 v35, v35
    v_exp_f32 v36, v36
    v_exp_f32 v37, v37
    v_exp_f32 v38, v38
    v_exp_f32 v39, v39
    v_mfma_f32_32x32x16_bf16 v[16:31], v[140:143], v[128:131], v[80:95]
    v_cvt_pk_bf16_f32 v120, v32, v33
    v_cvt_pk_bf16_f32 v121, v34, v35
    v_cvt_pk_bf16_f32 v122, v36, v37
    v_cvt_pk_bf16_f32 v123, v38, v39
    v_exp_f32 v40, v40
    v_exp_f32 v41, v41
    v_exp_f32 v42, v42
    v_exp_f32 v43, v43
    v_mfma_f32_32x32x16_bf16 v[64:79], v[144:147], v[120:123], v[64:79]
    v_exp_f32 v44, v44
    v_exp_f32 v45, v45
    v_exp_f32 v46, v46
    v_exp_f32 v47, v47
    v_cvt_pk_bf16_f32 v124, v40, v41
    v_cvt_pk_bf16_f32 v125, v42, v43
    v_cvt_pk_bf16_f32 v126, v44, v45
    v_cvt_pk_bf16_f32 v127, v46, v47
    v_exp_f32 v16, v16
    v_exp_f32 v17, v17
    v_mfma_f32_32x32x16_bf16 v[64:79], v[148:151], v[124:127], v[64:79]
    s_mov_b64 exec, s[60:61]
    ds_read_b128 v[144:147], v3 offset:17408
    ds_read_b128 v[148:151], v3 offset:17920
    s_mov_b64 exec, -1
    v_exp_f32 v18, v18
    v_exp_f32 v19, v19
    v_exp_f32 v20, v20
    v_exp_f32 v21, v21
    v_exp_f32 v22, v22
    v_exp_f32 v23, v23
    v_mfma_f32_32x32x16_bf16 v[32:47], v[140:143], v[132:135], v[96:111]
    ds_read_b128 v[140:143], v2 offset:20480
    v_cvt_pk_bf16_f32 v112, v16, v17
    v_cvt_pk_bf16_f32 v113, v18, v19
    v_cvt_pk_bf16_f32 v114, v20, v21
    v_cvt_pk_bf16_f32 v115, v22, v23
    v_exp_f32 v24, v24
    v_exp_f32 v25, v25
    v_exp_f32 v26, v26
    v_exp_f32 v27, v27
    s_waitcnt lgkmcnt(3)
    v_mfma_f32_32x32x16_bf16 v[48:63], v[152:155], v[112:115], v[48:63]
    v_exp_f32 v28, v28
    v_exp_f32 v29, v29
    v_exp_f32 v30, v30
    v_exp_f32 v31, v31
    v_cvt_pk_bf16_f32 v116, v24, v25
    v_cvt_pk_bf16_f32 v117, v26, v27
    v_cvt_pk_bf16_f32 v118, v28, v29
    v_cvt_pk_bf16_f32 v119, v30, v31
    v_exp_f32 v32, v32
    v_exp_f32 v33, v33
    v_mfma_f32_32x32x16_bf16 v[48:63], v[156:159], v[116:119], v[48:63]
    v_exp_f32 v34, v34
    v_exp_f32 v35, v35
    v_exp_f32 v36, v36
    v_exp_f32 v37, v37
    v_exp_f32 v38, v38
    v_exp_f32 v39, v39
    v_mfma_f32_32x32x16_bf16 v[16:31], v[136:139], v[128:131], v[80:95]
    v_cvt_pk_bf16_f32 v120, v32, v33
    v_cvt_pk_bf16_f32 v121, v34, v35
    v_cvt_pk_bf16_f32 v122, v36, v37
    v_cvt_pk_bf16_f32 v123, v38, v39
    v_exp_f32 v40, v40
    v_exp_f32 v41, v41
    v_exp_f32 v42, v42
    v_exp_f32 v43, v43
    v_mfma_f32_32x32x16_bf16 v[64:79], v[152:155], v[120:123], v[64:79]
    v_exp_f32 v44, v44
    v_exp_f32 v45, v45
    v_exp_f32 v46, v46
    v_exp_f32 v47, v47
    v_cvt_pk_bf16_f32 v124, v40, v41
    v_cvt_pk_bf16_f32 v125, v42, v43
    v_cvt_pk_bf16_f32 v126, v44, v45
    v_cvt_pk_bf16_f32 v127, v46, v47
    v_add_u32 v2, 16384, v2
    v_add_u32 v3, 16384, v3
    s_add_u32 s50, s50, 1
    s_cmp_lt_u32 s50, 8
    s_cbranch_scc1 a_loop
    v_mfma_f32_32x32x16_bf16 v[64:79], v[156:159], v[124:127], v[64:79]
    ds_write_b128 v160, v[48:51] offset:0
    ds_write_b128 v160, v[52:55] offset:1024
    ds_write_b32 v160, v56 offset:2048
    s_mov_b64 exec, 1
    ds_add_u32 v162, v11 offset:112
    s_mov_b64 exec, -1
    s_setprio 3
lw_5:
    ds_read_b32 v12, v163 offset:112
    s_waitcnt lgkmcnt(0)
    v_readfirstlane_b32 s51, v12
    s_nop 0
    s_cmp_ge_u32 s51, 1
    s_cbranch_scc1 lwd_6
    s_branch lw_5
lwd_6:
    ds_read_b128 v[16:19], v161 offset:0
    ds_read_b128 v[20:23], v161 offset:1024
    ds_read_b32 v24, v161 offset:2048
    s_mov_b32 s51, 0x7b800000
    s_mov_b32 s53, 0x15000000
    s_waitcnt lgkmcnt(0)
    v_add_f32 v72, v72, v24
    v_rcp_f32 v14, v72
    v_add_f32 v64, v64, v16
    v_add_f32 v65, v65, v17
    v_add_f32 v66, v66, v18
    v_add_f32 v67, v67, v19
    v_add_f32 v68, v68, v20
    v_add_f32 v69, v69, v21
    v_add_f32 v70, v70, v22
    v_add_f32 v71, v71, v23
    v_add_f32 v12, abs(v64), abs(v65)
    v_add_f32 v13, abs(v66), abs(v67)
    v_add_f32 v12, v12, abs(v68)
    v_add_f32 v13, v13, abs(v69)
    v_add_f32 v12, v12, abs(v70)
    v_add_f32 v13, v13, abs(v71)
    v_add_f32 v12, v12, v13
    v_add_f32 v13, v12, v72
    v_cmp_ngt_f32 vcc, s51, v13
    v_cmp_gt_f32 s[64:65], s53, v12
    s_nop 0
    s_or_b64 vcc, vcc, s[64:65]
    s_cbranch_vccnz a_fallback
a_norm:
    v_mul_f32 v64, v64, v14
    v_mul_f32 v65, v65, v14
    v_mul_f32 v66, v66, v14
    v_mul_f32 v67, v67, v14
    v_mul_f32 v68, v68, v14
    v_mul_f32 v69, v69, v14
    v_mul_f32 v70, v70, v14
    v_mul_f32 v71, v71, v14
    v_cvt_pk_bf16_f32 v112, v64, v65
    v_cvt_pk_bf16_f32 v113, v66, v67
    v_cvt_pk_bf16_f32 v114, v68, v69
    v_cvt_pk_bf16_f32 v115, v70, v71
    v_min_u32 v112, -2, v112
    v_min_u32 v113, -2, v113
    v_min_u32 v114, -2, v114
    v_min_u32 v115, -2, v115
    buffer_store_dwordx4 v[112:115], v9, s[36:39], s48 offen nt
    ds_write_b128 v164, v[112:115]
    s_mov_b64 exec, 1
    ds_add_u32 v10, v11 offset:144
    s_mov_b64 exec, -1
    s_mov_b32 s63, 40000
    s_cmp_eq_u32 s49, 0
    s_cbranch_scc1 nl_7
    buffer_store_dwordx4 v[112:115], v9, s[36:39], s44 offen sc1
    s_mov_b32 s63, 39980
    s_mov_b32 s49, 0
nl_7:
    s_mov_b32 s50, 0
a_poll:
    s_cmp_lt_u32 s63, 39988
    s_cselect_b32 s51, s63, 0
    s_bitcmp1_b32 s51, 0
    s_cselect_b32 s51, 0, 9437184
    v_add_u32 v13, s51, v9
    buffer_load_dwordx4 v[16:19], v13, s[36:39], s45 offen sc1
    buffer_load_dwordx4 v[20:23], v13, s[36:39], s46 offen sc1
    buffer_load_dwordx4 v[24:27], v13, s[36:39], s47 offen sc1
    s_sub_u32 s63, s63, 1
    s_waitcnt vmcnt(2)
    s_bitcmp1_b32 s50, 1
    s_cbranch_scc1 pn_8
    v_max3_u32 v12, v16, v17, v18
    v_max_u32 v12, v12, v19
    v_cmp_eq_u32 vcc, -1, v12
    s_cmp_eq_u32 s63, 0
    s_cselect_b64 vcc, 0, vcc
    s_cbranch_vccnz pn_8
    ds_write_b128 v165, v[16:19] offset:8192
    s_mov_b64 exec, 1
    ds_add_u32 v10, v11 offset:148
    s_mov_b64 exec, -1
    s_bitset1_b32 s50, 1
pn_8:
    s_waitcnt vmcnt(1)
    s_bitcmp1_b32 s50, 2
    s_cbranch_scc1 pn_9
    v_max3_u32 v12, v20, v21, v22
    v_max_u32 v12, v12, v23
    v_cmp_eq_u32 vcc, -1, v12
    s_cmp_eq_u32 s63, 0
    s_cselect_b64 vcc, 0, vcc
    s_cbranch_vccnz pn_9
    ds_write_b128 v165, v[20:23] offset:16384
    s_mov_b64 exec, 1
    ds_add_u32 v10, v11 offset:152
    s_mov_b64 exec, -1
    s_bitset1_b32 s50, 2
pn_9:
    s_waitcnt vmcnt(0)
    s_bitcmp1_b32 s50, 3
    s_cbranch_scc1 pn_10
    v_max3_u32 v12, v24, v25, v26
    v_max_u32 v12, v12, v27
    v_cmp_eq_u32 vcc, -1, v12
    s_cmp_eq_u32 s63, 0
    s_cselect_b64 vcc, 0, vcc
    s_cbranch_vccnz pn_10
    ds_write_b128 v165, v[24:27] offset:24576
    s_mov_b64 exec, 1
    ds_add_u32 v10, v11 offset:156
    s_mov_b64 exec, -1
    s_bitset1_b32 s50, 3
pn_10:
    s_cmp_eq_u32 s50, 14
    s_cbranch_scc1 a_got
    s_cmp_eq_u32 s63, 39996
    s_cbranch_scc0 sl_11
    buffer_store_dwordx4 v[112:115], v9, s[36:39], s44 offen sc1
sl_11:
    s_branch a_poll
a_got:
    s_cmp_eq_u32 s49, 0
    s_cbranch_scc1 a_done
    buffer_store_dwordx4 v[112:115], v9, s[36:39], s44 offen sc1
a_done:
    s_endpgm
a_hk_lo:
    s_cmp_eq_u32 s50, 0
    s_cbranch_scc0 hk_12
lw_13:
    ds_read_b32 v12, v10 offset:20
    s_waitcnt lgkmcnt(0)
    v_readfirstlane_b32 s51, v12
    s_nop 0
    s_cmp_ge_u32 s51, 4
    s_cbranch_scc1 lwd_14
    s_sleep 1
    s_branch lw_13
lwd_14:
    s_branch a_hk_done
hk_12:
    s_cmp_eq_u32 s50, 1
    s_cbranch_scc0 hk_15
lw_16:
    ds_read_b32 v12, v10 offset:24
    s_waitcnt lgkmcnt(0)
    v_readfirstlane_b32 s51, v12
    s_nop 0
    s_cmp_ge_u32 s51, 4
    s_cbranch_scc1 lwd_17
    s_sleep 1
    s_branch lw_16
lwd_17:
    s_branch a_hk_done
hk_15:
    s_cmp_eq_u32 s50, 2
    s_cbranch_scc0 hk_18
    s_xor_b32 s52, s59, 4
    s_mul_i32 s53, s59, 3072
    v_add_u32 v160, s53, v9
    s_mul_i32 s53, s52, 3072
    v_add_u32 v161, s53, v9
    s_lshl_b32 s53, s59, 2
    v_add_u32 v162, s53, v10
    s_lshl_b32 s53, s52, 2
    v_add_u32 v163, s53, v10
    s_lshl_b32 s57, s42, 1
    s_add_u32 s57, s57, s43
    s_lshl_b32 s58, s40, 5
    s_lshl_b32 s53, s41, 3
    s_add_u32 s53, s53, s58
    s_add_u32 s53, s53, s57
    s_lshl_b32 s53, s53, 10
    s_add_u32 s44, s53, 1048576
    s_lshl_b32 s57, s57, 10
    s_add_u32 s57, s57, 65536
    v_add_u32 v164, s57, v9
    s_add_u32 s48, s44, 9437184
    s_lshl_b32 s57, s59, 10
    s_add_u32 s57, s57, 65536
    v_add_u32 v165, s57, v9
    s_add_u32 s51, s41, 1
    s_and_b32 s51, s51, 3
    s_lshl_b32 s51, s51, 3
    s_add_u32 s51, s51, s58
    s_add_u32 s51, s51, s59
    s_lshl_b32 s51, s51, 10
    s_add_u32 s45, s51, 1048576
    s_add_u32 s51, s41, 2
    s_and_b32 s51, s51, 3
    s_lshl_b32 s51, s51, 3
    s_add_u32 s51, s51, s58
    s_add_u32 s51, s51, s59
    s_lshl_b32 s51, s51, 10
    s_add_u32 s46, s51, 1048576
    s_add_u32 s51, s41, 3
    s_and_b32 s51, s51, 3
    s_lshl_b32 s51, s51, 3
    s_add_u32 s51, s51, s58
    s_add_u32 s51, s51, s59
    s_lshl_b32 s51, s51, 10
    s_add_u32 s47, s51, 1048576
    s_branch a_hk_done
hk_18:
    s_cmp_eq_u32 s50, 3
    s_cbranch_scc0 hk_19
    s_cmp_eq_u32 s43, 0
    s_cbranch_scc0 pp_20
    s_setprio 2
pp_20:
    s_mov_b64 exec, 1
    ds_add_u32 v10, v11 offset:104
    s_mov_b64 exec, -1
    s_branch a_hk_done
hk_19:
    s_branch a_hk_done
a_hk_hi:
    s_cmp_eq_u32 s50, 4
    s_cbranch_scc0 hk_21
    s_cmp_eq_u32 s43, 1
    s_cbranch_scc0 pp_22
    s_setprio 2
pp_22:
    s_branch a_hk_done
hk_21:
    s_cmp_eq_u32 s50, 5
    s_cbranch_scc0 hk_23
    s_cmp_eq_u32 s43, 0
    s_cbranch_scc0 pp_24
    s_setprio 1
pp_24:
lw_25:
    ds_read_b32 v12, v10 offset:28
    s_waitcnt lgkmcnt(0)
    v_readfirstlane_b32 s51, v12
    s_nop 0
    s_cmp_ge_u32 s51, 4
    s_cbranch_scc1 lwd_26
    s_sleep 1
    s_branch lw_25
lwd_26:
    s_branch a_hk_done
hk_23:
    s_cmp_eq_u32 s50, 6
    s_cbranch_scc0 hk_27
    s_cmp_eq_u32 s43, 0
    s_cbranch_scc0 pp_28
    s_setprio 0
pp_28:
    s_cmp_eq_u32 s43, 1
    s_cbranch_scc0 pp_29
    s_setprio 1
pp_29:
    s_mov_b64 exec, 1
    ds_add_u32 v10, v11 offset:108
    s_mov_b64 exec, -1
    s_branch a_hk_done
hk_27:
    s_cmp_eq_u32 s50, 7
    s_cbranch_scc0 hk_30
    s_cmp_eq_u32 s43, 1
    s_cbranch_scc0 pp_31
    s_setprio 0
pp_31:
lw_32:
    ds_read_b32 v12, v10 offset:32
    s_waitcnt lgkmcnt(0)
    v_readfirstlane_b32 s51, v12
    s_nop 0
    s_cmp_ge_u32 s51, 4
    s_cbranch_scc1 lwd_33
    s_sleep 1
    s_branch lw_32
lwd_33:
lw_34:
    ds_read_b32 v12, v10 offset:108
    s_waitcnt lgkmcnt(0)
    v_readfirstlane_b32 s51, v12
    s_nop 0
    s_cmp_ge_u32 s51, 8
    s_cbranch_scc1 lwd_35
    s_sleep 1
    s_branch lw_34
lwd_35:
    ds_read_b32 v12, v10 offset:160
    s_waitcnt lgkmcnt(0)
    v_readfirstlane_b32 s49, v12
    v_lshlrev_b32 v13, 7, v1
    v_add_u32 v13, 9437184, v13
    s_mov_b64 exec, 0xff
    buffer_load_dword v166, v13, s[36:39], s45 offen sc1
    buffer_load_dword v166, v13, s[36:39], s46 offen sc1
    buffer_load_dword v166, v13, s[36:39], s47 offen sc1
    s_mov_b64 exec, -1
    s_branch a_hk_done
hk_30:
    s_branch a_hk_done
a_fallback:
    v_mov_b32 v12, 0xff800000
    s_mov_b32 s50, 0
a_fb1:
    buffer_load_dwordx4 v[136:139], v9, s[36:39], s50 offen sc1
    s_waitcnt vmcnt(0)
    v_mfma_f32_32x32x16_bf16 v[16:31], v[136:139], v[132:135], 0
    s_add_u32 s50, s50, 2048
    s_nop 10
    v_max3_f32 v12, v12, v16, v17
    v_max3_f32 v12, v12, v18, v19
    v_max3_f32 v12, v12, v20, v21
    v_max3_f32 v12, v12, v22, v23
    v_max3_f32 v12, v12, v24, v25
    v_max3_f32 v12, v12, v26, v27
    v_max3_f32 v12, v12, v28, v29
    v_max3_f32 v12, v12, v30, v31
    s_cmp_lt_u32 s50, 0x20000
    s_cbranch_scc1 a_fb1
    v_mov_b32 v13, v12
    s_nop 1
    v_permlane32_swap_b32 v12, v13
    v_max_f32 v12, v12, v13
    v_sub_f32 v80, 0, v12
    v_mov_b32 v81, v80
    v_mov_b32 v82, v80
    v_mov_b32 v83, v80
    v_mov_b32 v84, v80
    v_mov_b32 v85, v80
    v_mov_b32 v86, v80
    v_mov_b32 v87, v80
    v_mov_b32 v88, v80
    v_mov_b32 v89, v80
    v_mov_b32 v90, v80
    v_mov_b32 v91, v80
    v_mov_b32 v92, v80
    v_mov_b32 v93, v80
    v_mov_b32 v94, v80
    v_mov_b32 v95, v80
    v_mov_b32 v64, 0
    v_mov_b32 v65, 0
    v_mov_b32 v66, 0
    v_mov_b32 v67, 0
    v_mov_b32 v68, 0
    v_mov_b32 v69, 0
    v_mov_b32 v70, 0
    v_mov_b32 v71, 0
    v_mov_b32 v72, 0
    v_mov_b32 v73, 0
    v_mov_b32 v74, 0
    v_mov_b32 v75, 0
    v_mov_b32 v76, 0
    v_mov_b32 v77, 0
    v_mov_b32 v78, 0
    v_mov_b32 v79, 0
    v_lshlrev_b32 v3, 8, v7
    v_lshl_add_u32 v3, v6, 4, v3
    s_mov_b32 s50, 0
a_fb2:
    buffer_load_dwordx4 v[136:139], v9, s[36:39], s50 offen sc1
    s_mov_b64 exec, s[60:61]
    buffer_load_dwordx4 v[144:147], v3, s[36:39], s50 offen offset:1024 sc1
    buffer_load_dwordx4 v[148:151], v3, s[36:39], s50 offen offset:1536 sc1
    s_mov_b64 exec, -1
    s_waitcnt vmcnt(0)
    v_mfma_f32_32x32x16_bf16 v[16:31], v[136:139], v[132:135], v[80:95]
    s_add_u32 s50, s50, 2048
    s_nop 10
    v_exp_f32 v16, v16
    v_exp_f32 v17, v17
    v_exp_f32 v18, v18
    v_exp_f32 v19, v19
    v_exp_f32 v20, v20
    v_exp_f32 v21, v21
    v_exp_f32 v22, v22
    v_exp_f32 v23, v23
    v_exp_f32 v24, v24
    v_exp_f32 v25, v25
    v_exp_f32 v26, v26
    v_exp_f32 v27, v27
    v_exp_f32 v28, v28
    v_exp_f32 v29, v29
    v_exp_f32 v30, v30
    v_exp_f32 v31, v31
    v_cvt_pk_bf16_f32 v112, v16, v17
    v_cvt_pk_bf16_f32 v113, v18, v19
    v_cvt_pk_bf16_f32 v114, v20, v21
    v_cvt_pk_bf16_f32 v115, v22, v23
    v_cvt_pk_bf16_f32 v116, v24, v25
    v_cvt_pk_bf16_f32 v117, v26, v27
    v_cvt_pk_bf16_f32 v118, v28, v29
    v_cvt_pk_bf16_f32 v119, v30, v31
    v_mfma_f32_32x32x16_bf16 v[64:79], v[144:147], v[112:115], v[64:79]
    s_nop 0
    v_mfma_f32_32x32x16_bf16 v[64:79], v[148:151], v[116:119], v[64:79]
    s_cmp_lt_u32 s50, 0x20000
    s_cbranch_scc1 a_fb2
    s_nop 9
    v_rcp_f32 v14, v72
    s_branch a_norm
role_b:
    s_mov_b32 s58, 0
    s_lshr_b32 s44, s40, 1
    s_and_b32 s42, s26, 1
    s_lshr_b32 s43, s26, 1
    s_mov_b32 s28, s14
    s_mov_b32 s29, s15
    s_mov_b32 s30, 2097152
    s_mov_b32 s31, 0x20000
    s_mov_b32 s32, s16
    s_mov_b32 s33, s17
    s_mov_b32 s34, 1572864
    s_mov_b32 s35, 0x20000
    v_lshrrev_b32 v12, 3, v1
    v_and_b32 v13, 7, v1
    v_bfe_u32 v14, v1, 4, 1
    v_lshlrev_b32 v14, 2, v14
    v_xor_b32 v14, v14, v13
    v_mul_u32_u24 v3, 3072, v12
    v_lshl_add_u32 v3, v14, 4, v3
    v_lshlrev_b32 v4, 10, v12
    v_lshl_add_u32 v4, v14, 4, v4
    s_mul_i32 s64, s26, 49152
    s_lshl_b32 s51, s27, 7
    s_add_u32 s64, s64, s51
    s_lshl_b32 s65, s44, 16
    s_lshl_b32 s51, s26, 14
    s_add_u32 s65, s65, s51
    s_lshr_b32 s67, s3, 3
    s_lshl_b32 s67, s67, 1
    s_add_u32 s67, s67, s3
    s_and_b32 s67, s67, 7
    s_mul_i32 s56, s26, 6144
    s_add_u32 s56, s56, 97792
    s_mul_i32 s57, s26, 2080
    s_add_u32 s57, s57, 122368
    v_lshl_add_u32 v5, v1, 2, v10
    v_mov_b32 v12, 0
    ds_write_b32 v5, v12
    v_and_b32 v12, 15, v1
    v_lshrrev_b32 v13, 4, v1
    v_mul_u32_u24 v14, 1040, v12
    v_lshl_add_u32 v14, v13, 4, v14
    s_mul_i32 s51, s46, 16640
    s_add_u32 s51, s51, 16384
    v_add_u32 v14, s51, v14
    v_lshlrev_b32 v15, 8, v13
    v_lshl_add_u32 v15, v12, 3, v15
    v_and_b32 v16, 1, v13
    s_cmp_eq_u32 s45, 0
    s_cselect_b32 s51, 9, 8
    s_cselect_b32 s52, 8, 9
    s_lshl_b32 s52, s46, s52
    s_lshl_b32 s53, s45, 10
    s_add_u32 s52, s52, s53
    s_lshl_b32 s53, s40, 11
    s_add_u32 s52, s52, s53
    v_lshlrev_b32 v16, s51, v16
    v_lshl_add_u32 v16, v12, 4, v16
    v_lshrrev_b32 v17, 1, v13
    v_lshl_add_u32 v16, v17, 3, v16
    s_lshl_b32 s53, s40, 7
    s_lshl_b32 s54, s41, 2
    s_add_u32 s53, s53, s54
    s_add_u32 s53, s53, 131072
    v_lshlrev_b32 v17, 1, v16
    s_lshl_b32 s54, s52, 1
    s_add_u32 s54, s54, 262144
    s_waitcnt vmcnt(0) lgkmcnt(0)
    v_readfirstlane_b32 s62, v19
    s_nop 0
    s_add_u32 s62, s62, -1640531527
    s_barrier
    s_cmp_eq_u32 s26, 3
    s_cbranch_scc0 nokv_36
    s_cmp_eq_u32 s45, 0
    s_cbranch_scc0 kv_v_37
    ds_read_b128 v[24:27], v14 offset:0
    ds_read_b64_tr_b16 v[88:89], v15 offset:0
    ds_read_b64_tr_b16 v[90:91], v15 offset:128
    ds_read_b128 v[28:31], v14 offset:64
    ds_read_b64_tr_b16 v[92:93], v15 offset:1024
    ds_read_b64_tr_b16 v[94:95], v15 offset:1152
    ds_read_b128 v[32:35], v14 offset:128
    ds_read_b64_tr_b16 v[96:97], v15 offset:2048
    ds_read_b64_tr_b16 v[98:99], v15 offset:2176
    ds_read_b128 v[36:39], v14 offset:192
    ds_read_b64_tr_b16 v[100:101], v15 offset:3072
    ds_read_b64_tr_b16 v[102:103], v15 offset:3200
    ds_read_b128 v[40:43], v14 offset:256
    ds_read_b64_tr_b16 v[104:105], v15 offset:4096
    ds_read_b64_tr_b16 v[106:107], v15 offset:4224
    s_waitcnt lgkmcnt(12)
    v_mfma_f32_16x16x32_bf16 v[20:23], v[88:91], v[24:27], 0
    ds_read_b128 v[44:47], v14 offset:320
    ds_read_b64_tr_b16 v[108:109], v15 offset:5120
    ds_read_b64_tr_b16 v[110:111], v15 offset:5248
    s_waitcnt lgkmcnt(12)
    v_mfma_f32_16x16x32_bf16 v[20:23], v[92:95], v[28:31], v[20:23]
    ds_read_b128 v[48:51], v14 offset:384
    ds_read_b64_tr_b16 v[112:113], v15 offset:6144
    ds_read_b64_tr_b16 v[114:115], v15 offset:6272
    s_waitcnt lgkmcnt(12)
    v_mfma_f32_16x16x32_bf16 v[20:23], v[96:99], v[32:35], v[20:23]
    ds_read_b128 v[52:55], v14 offset:448
    ds_read_b64_tr_b16 v[116:117], v15 offset:7168
    ds_read_b64_tr_b16 v[118:119], v15 offset:7296
    s_waitcnt lgkmcnt(12)
    v_mfma_f32_16x16x32_bf16 v[20:23], v[100:103], v[36:39], v[20:23]
    ds_read_b128 v[56:59], v14 offset:512
    ds_read_b64_tr_b16 v[120:121], v15 offset:8192
    ds_read_b64_tr_b16 v[122:123], v15 offset:8320
    s_waitcnt lgkmcnt(12)
    v_mfma_f32_16x16x32_bf16 v[20:23], v[104:107], v[40:43], v[20:23]
    ds_read_b128 v[60:63], v14 offset:576
    ds_read_b64_tr_b16 v[124:125], v15 offset:9216
    ds_read_b64_tr_b16 v[126:127], v15 offset:9344
    s_waitcnt lgkmcnt(12)
    v_mfma_f32_16x16x32_bf16 v[20:23], v[108:111], v[44:47], v[20:23]
    ds_read_b128 v[64:67], v14 offset:640
    ds_read_b64_tr_b16 v[128:129], v15 offset:10240
    ds_read_b64_tr_b16 v[130:131], v15 offset:10368
    s_waitcnt lgkmcnt(12)
    v_mfma_f32_16x16x32_bf16 v[20:23], v[112:115], v[48:51], v[20:23]
    ds_read_b128 v[68:71], v14 offset:704
    ds_read_b64_tr_b16 v[132:133], v15 offset:11264
    ds_read_b64_tr_b16 v[134:135], v15 offset:11392
    s_waitcnt lgkmcnt(12)
    v_mfma_f32_16x16x32_bf16 v[20:23], v[116:119], v[52:55], v[20:23]
    ds_read_b128 v[72:75], v14 offset:768
    ds_read_b64_tr_b16 v[136:137], v15 offset:12288
    ds_read_b64_tr_b16 v[138:139], v15 offset:12416
    s_waitcnt lgkmcnt(12)
    v_mfma_f32_16x16x32_bf16 v[20:23], v[120:123], v[56:59], v[20:23]
    ds_read_b128 v[76:79], v14 offset:832
    ds_read_b64_tr_b16 v[140:141], v15 offset:13312
    ds_read_b64_tr_b16 v[142:143], v15 offset:13440
    s_waitcnt lgkmcnt(12)
    v_mfma_f32_16x16x32_bf16 v[20:23], v[124:127], v[60:63], v[20:23]
    ds_read_b128 v[80:83], v14 offset:896
    ds_read_b64_tr_b16 v[144:145], v15 offset:14336
    ds_read_b64_tr_b16 v[146:147], v15 offset:14464
    s_waitcnt lgkmcnt(12)
    v_mfma_f32_16x16x32_bf16 v[20:23], v[128:131], v[64:67], v[20:23]
    ds_read_b128 v[84:87], v14 offset:960
    ds_read_b64_tr_b16 v[148:149], v15 offset:15360
    ds_read_b64_tr_b16 v[150:151], v15 offset:15488
    s_waitcnt lgkmcnt(12)
    v_mfma_f32_16x16x32_bf16 v[20:23], v[132:135], v[68:71], v[20:23]
    s_waitcnt lgkmcnt(9)
    v_mfma_f32_16x16x32_bf16 v[20:23], v[136:139], v[72:75], v[20:23]
    s_waitcnt lgkmcnt(6)
    v_mfma_f32_16x16x32_bf16 v[20:23], v[140:143], v[76:79], v[20:23]
    s_waitcnt lgkmcnt(3)
    v_mfma_f32_16x16x32_bf16 v[20:23], v[144:147], v[80:83], v[20:23]
    s_waitcnt lgkmcnt(0)
    v_mfma_f32_16x16x32_bf16 v[20:23], v[148:151], v[84:87], v[20:23]
    s_branch kv_d_38
kv_v_37:
    ds_read_b128 v[24:27], v14 offset:0
    ds_read_b64_tr_b16 v[88:89], v15 offset:0
    ds_read_b64_tr_b16 v[90:91], v15 offset:128
    ds_read_b128 v[28:31], v14 offset:64
    ds_read_b64_tr_b16 v[92:93], v15 offset:1024
    ds_read_b64_tr_b16 v[94:95], v15 offset:1152
    ds_read_b128 v[32:35], v14 offset:128
    ds_read_b64_tr_b16 v[96:97], v15 offset:2048
    ds_read_b64_tr_b16 v[98:99], v15 offset:2176
    ds_read_b128 v[36:39], v14 offset:192
    ds_read_b64_tr_b16 v[100:101], v15 offset:3072
    ds_read_b64_tr_b16 v[102:103], v15 offset:3200
    ds_read_b128 v[40:43], v14 offset:256
    ds_read_b64_tr_b16 v[104:105], v15 offset:4096
    ds_read_b64_tr_b16 v[106:107], v15 offset:4224
    s_waitcnt lgkmcnt(12)
    v_mfma_f32_16x16x32_bf16 v[20:23], v[24:27], v[88:91], 0
    ds_read_b128 v[44:47], v14 offset:320
    ds_read_b64_tr_b16 v[108:109], v15 offset:5120
    ds_read_b64_tr_b16 v[110:111], v15 offset:5248
    s_waitcnt lgkmcnt(12)
    v_mfma_f32_16x16x32_bf16 v[20:23], v[28:31], v[92:95], v[20:23]
    ds_read_b128 v[48:51], v14 offset:384
    ds_read_b64_tr_b16 v[112:113], v15 offset:6144
    ds_read_b64_tr_b16 v[114:115], v15 offset:6272
    s_waitcnt lgkmcnt(12)
    v_mfma_f32_16x16x32_bf16 v[20:23], v[32:35], v[96:99], v[20:23]
    ds_read_b128 v[52:55], v14 offset:448
    ds_read_b64_tr_b16 v[116:117], v15 offset:7168
    ds_read_b64_tr_b16 v[118:119], v15 offset:7296
    s_waitcnt lgkmcnt(12)
    v_mfma_f32_16x16x32_bf16 v[20:23], v[36:39], v[100:103], v[20:23]
    ds_read_b128 v[56:59], v14 offset:512
    ds_read_b64_tr_b16 v[120:121], v15 offset:8192
    ds_read_b64_tr_b16 v[122:123], v15 offset:8320
    s_waitcnt lgkmcnt(12)
    v_mfma_f32_16x16x32_bf16 v[20:23], v[40:43], v[104:107], v[20:23]
    ds_read_b128 v[60:63], v14 offset:576
    ds_read_b64_tr_b16 v[124:125], v15 offset:9216
    ds_read_b64_tr_b16 v[126:127], v15 offset:9344
    s_waitcnt lgkmcnt(12)
    v_mfma_f32_16x16x32_bf16 v[20:23], v[44:47], v[108:111], v[20:23]
    ds_read_b128 v[64:67], v14 offset:640
    ds_read_b64_tr_b16 v[128:129], v15 offset:10240
    ds_read_b64_tr_b16 v[130:131], v15 offset:10368
    s_waitcnt lgkmcnt(12)
    v_mfma_f32_16x16x32_bf16 v[20:23], v[48:51], v[112:115], v[20:23]
    ds_read_b128 v[68:71], v14 offset:704
    ds_read_b64_tr_b16 v[132:133], v15 offset:11264
    ds_read_b64_tr_b16 v[134:135], v15 offset:11392
    s_waitcnt lgkmcnt(12)
    v_mfma_f32_16x16x32_bf16 v[20:23], v[52:55], v[116:119], v[20:23]
    ds_read_b128 v[72:75], v14 offset:768
    ds_read_b64_tr_b16 v[136:137], v15 offset:12288
    ds_read_b64_tr_b16 v[138:139], v15 offset:12416
    s_waitcnt lgkmcnt(12)
    v_mfma_f32_16x16x32_bf16 v[20:23], v[56:59], v[120:123], v[20:23]
    ds_read_b128 v[76:79], v14 offset:832
    ds_read_b64_tr_b16 v[140:141], v15 offset:13312
    ds_read_b64_tr_b16 v[142:143], v15 offset:13440
    s_waitcnt lgkmcnt(12)
    v_mfma_f32_16x16x32_bf16 v[20:23], v[60:63], v[124:127], v[20:23]
    ds_read_b128 v[80:83], v14 offset:896
    ds_read_b64_tr_b16 v[144:145], v15 offset:14336
    ds_read_b64_tr_b16 v[146:147], v15 offset:14464
    s_waitcnt lgkmcnt(12)
    v_mfma_f32_16x16x32_bf16 v[20:23], v[64:67], v[128:131], v[20:23]
    ds_read_b128 v[84:87], v14 offset:960
    ds_read_b64_tr_b16 v[148:149], v15 offset:15360
    ds_read_b64_tr_b16 v[150:151], v15 offset:15488
    s_waitcnt lgkmcnt(12)
    v_mfma_f32_16x16x32_bf16 v[20:23], v[68:71], v[132:135], v[20:23]
    s_waitcnt lgkmcnt(9)
    v_mfma_f32_16x16x32_bf16 v[20:23], v[72:75], v[136:139], v[20:23]
    s_waitcnt lgkmcnt(6)
    v_mfma_f32_16x16x32_bf16 v[20:23], v[76:79], v[140:143], v[20:23]
    s_waitcnt lgkmcnt(3)
    v_mfma_f32_16x16x32_bf16 v[20:23], v[80:83], v[144:147], v[20:23]
    s_waitcnt lgkmcnt(0)
    v_mfma_f32_16x16x32_bf16 v[20:23], v[84:87], v[148:151], v[20:23]
kv_d_38:
    s_barrier
    s_cmp_eq_u32 s45, 0
    s_cselect_b32 s51, 1.0, 0x53800000
    s_nop 4
    v_mul_f32 v20, s51, v20
    v_mul_f32 v21, s51, v21
    v_mul_f32 v22, s51, v22
    v_mul_f32 v23, s51, v23
    v_cvt_pk_bf16_f32 v156, v20, v21
    v_cvt_pk_bf16_f32 v157, v22, v23
    v_xor_b32 v158, s62, v156
    v_xor_b32 v159, s62, v157
    buffer_store_dwordx4 v[156:159], v17, s[36:39], s54 offen
    buffer_store_dwordx2 v[156:157], v16, s[36:39], s52 offen sc1
    s_branch kvs_39
nokv_36:
    s_barrier
kvs_39:
    s_mov_b32 s45, s27
    v_mul_u32_u24 v8, 3072, v7
    v_bfe_u32 v14, v1, 2, 2
    v_lshl_add_u32 v8, v14, 7, v8
    v_bfe_u32 v14, v1, 3, 1
    v_xor_b32 v14, s42, v14
    v_lshl_add_u32 v8, v14, 6, v8
    v_bfe_u32 v14, v1, 4, 1
    v_lshl_add_u32 v8, v14, 5, v8
    v_and_b32 v14, 3, v1
    v_lshl_add_u32 v8, v14, 3, v8
    v_add_u32 v8, 97792, v8
    v_bfe_u32 v14, v1, 1, 1
    v_lshlrev_b32 v14, 2, v14
    v_or_b32 v14, v14, v7
    v_lshlrev_b32 v14, 4, v14
    v_and_b32 v15, 7, v1
    v_lshl_add_u32 v14, v15, 7, v14
    v_xor_b32 v15, 64, v14
    v_lshrrev_b32 v16, 3, v6
    v_mul_u32_u24 v16, 1040, v16
    s_mul_i32 s51, s43, 4160
    s_add_u32 s51, s51, 122368
    v_add3_u32 v152, v14, v16, s51
    v_add3_u32 v153, v15, v16, s51
    v_mov_b32 v20, 0
    v_mov_b32 v21, 0
    v_mov_b32 v22, 0
    v_mov_b32 v23, 0
    v_mov_b32 v24, 0
    v_mov_b32 v25, 0
    v_mov_b32 v26, 0
    v_mov_b32 v27, 0
    v_mov_b32 v28, 0
    v_mov_b32 v29, 0
    v_mov_b32 v30, 0
    v_mov_b32 v31, 0
    v_mov_b32 v32, 0
    v_mov_b32 v33, 0
    v_mov_b32 v34, 0
    v_mov_b32 v35, 0
    v_mov_b32 v36, 0
    v_mov_b32 v37, 0
    v_mov_b32 v38, 0
    v_mov_b32 v39, 0
    v_mov_b32 v40, 0
    v_mov_b32 v41, 0
    v_mov_b32 v42, 0
    v_mov_b32 v43, 0
    v_mov_b32 v44, 0
    v_mov_b32 v45, 0
    v_mov_b32 v46, 0
    v_mov_b32 v47, 0
    v_mov_b32 v48, 0
    v_mov_b32 v49, 0
    v_mov_b32 v50, 0
    v_mov_b32 v51, 0
    v_mov_b32 v52, 0
    v_mov_b32 v53, 0
    v_mov_b32 v54, 0
    v_mov_b32 v55, 0
    v_mov_b32 v56, 0
    v_mov_b32 v57, 0
    v_mov_b32 v58, 0
    v_mov_b32 v59, 0
    v_mov_b32 v60, 0
    v_mov_b32 v61, 0
    v_mov_b32 v62, 0
    v_mov_b32 v63, 0
    v_mov_b32 v64, 0
    v_mov_b32 v65, 0
    v_mov_b32 v66, 0
    v_mov_b32 v67, 0
    v_mov_b32 v96, 0
    v_mov_b32 v97, 0
    v_mov_b32 v98, 0
    v_mov_b32 v99, 0
    v_mov_b32 v100, 0
    v_mov_b32 v101, 0
    v_mov_b32 v102, 0
    v_mov_b32 v103, 0
    v_mov_b32 v104, 0
    v_mov_b32 v105, 0
    v_mov_b32 v106, 0
    v_mov_b32 v107, 0
    v_mov_b32 v112, 0
    v_mov_b32 v113, 0
    v_mov_b32 v114, 0
    v_mov_b32 v115, 0
    s_barrier
    s_cmp_eq_u32 s26, 3
    s_cbranch_scc0 kvf_40
    s_waitcnt vmcnt(0)
    v_mov_b32 v18, s62
    v_mov_b32 v19, 0
    s_mov_b64 exec, 1
    buffer_store_dword v18, v19, s[36:39], s53 offen sc1
    s_mov_b64 exec, -1
kvf_40:
    s_barrier
    s_mul_i32 s51, s26, 6144
    s_add_u32 s51, s51, 131072
    v_lshlrev_b32 v15, 3, v7
    v_sub_u32 v15, v6, v15
    v_add_u32 v15, 10, v15
    v_add_u32 v126, s51, v9
    v_lshlrev_b32 v14, 4, v6
    v_add_u32 v14, s51, v14
    v_add_u32 v16, 0, v15
    v_lshrrev_b32 v17, 2, v16
    v_lshl_add_u32 v144, v17, 9, v14
    v_lshrrev_b32 v17, 4, v16
    v_lshl_add_u32 v128, v17, 10, v14
    v_bfe_u32 v17, v16, 2, 1
    v_lshl_add_u32 v128, v17, 9, v128
    v_bfe_u32 v17, v16, 3, 1
    v_lshl_add_u32 v128, v17, 3, v128
    v_and_b32 v17, 3, v16
    v_lshl_add_u32 v128, v17, 1, v128
    v_lshl_add_u32 v144, v17, 2, v144
    v_add_u32 v16, 2, v15
    v_lshrrev_b32 v17, 2, v16
    v_lshl_add_u32 v145, v17, 9, v14
    v_lshrrev_b32 v17, 4, v16
    v_lshl_add_u32 v129, v17, 10, v14
    v_bfe_u32 v17, v16, 2, 1
    v_lshl_add_u32 v129, v17, 9, v129
    v_bfe_u32 v17, v16, 3, 1
    v_lshl_add_u32 v129, v17, 3, v129
    v_and_b32 v17, 3, v16
    v_lshl_add_u32 v129, v17, 1, v129
    v_lshl_add_u32 v145, v17, 2, v145
    v_add_u32 v16, 4, v15
    v_lshrrev_b32 v17, 2, v16
    v_lshl_add_u32 v146, v17, 9, v14
    v_lshrrev_b32 v17, 4, v16
    v_lshl_add_u32 v130, v17, 10, v14
    v_bfe_u32 v17, v16, 2, 1
    v_lshl_add_u32 v130, v17, 9, v130
    v_bfe_u32 v17, v16, 3, 1
    v_lshl_add_u32 v130, v17, 3, v130
    v_and_b32 v17, 3, v16
    v_lshl_add_u32 v130, v17, 1, v130
    v_lshl_add_u32 v146, v17, 2, v146
    v_add_u32 v16, 6, v15
    v_lshrrev_b32 v17, 2, v16
    v_lshl_add_u32 v147, v17, 9, v14
    v_lshrrev_b32 v17, 4, v16
    v_lshl_add_u32 v131, v17, 10, v14
    v_bfe_u32 v17, v16, 2, 1
    v_lshl_add_u32 v131, v17, 9, v131
    v_bfe_u32 v17, v16, 3, 1
    v_lshl_add_u32 v131, v17, 3, v131
    v_and_b32 v17, 3, v16
    v_lshl_add_u32 v131, v17, 1, v131
    v_lshl_add_u32 v147, v17, 2, v147
    v_mov_b32 v132, 0
    v_mov_b32 v133, 0
    v_mov_b32 v134, 0
    v_mov_b32 v135, 0
    s_lshr_b32 s55, s40, 3
    s_lshl_b32 s55, s55, 2
    s_cmp_ge_u32 s3, 28
    s_cselect_b32 s51, 28, 0
    s_sub_u32 s59, s3, s51
    s_add_u32 s53, s55, s26
    s_lshl_b32 s53, s53, 13
    s_add_u32 s53, s53, 262144
    s_add_u32 s52, s53, 4096
    s_lshl_b32 s51, s26, 12
    v_lshlrev_b32 v13, 3, v1
    v_add_u32 v13, s51, v13
    s_mov_b32 s63, 3
    s_mov_b32 s46, 0
    s_barrier
    buffer_load_dwordx4 v[68:71], v9, s[36:39], s53 offen offset:0 sc1
    buffer_load_dwordx4 v[72:75], v9, s[36:39], s53 offen offset:1024 sc1
    buffer_load_dwordx4 v[76:79], v9, s[36:39], s53 offen offset:2048 sc1
    buffer_load_dwordx4 v[80:83], v9, s[36:39], s53 offen offset:3072 sc1
    buffer_load_dwordx4 v[84:87], v9, s[36:39], s52 offen offset:0 sc1
    buffer_load_dwordx4 v[88:91], v9, s[36:39], s52 offen offset:1024 sc1
    buffer_load_dwordx4 v[92:95], v9, s[36:39], s52 offen offset:2048 sc1
    buffer_load_dwordx4 v[108:111], v9, s[36:39], s52 offen offset:3072 sc1
    s_barrier
b_kf:
    v_mov_b32 v14, 0
    s_waitcnt vmcnt(7)
    ds_write_b64 v13, v[68:69] offset:0
    v_bitop3_b32 v15, v68, v70, s62 bitop3:0x96
    v_bitop3_b32 v16, v69, v71, s62 bitop3:0x96
    v_or3_b32 v14, v14, v15, v16
    s_waitcnt vmcnt(6)
    ds_write_b64 v13, v[72:73] offset:512
    v_bitop3_b32 v15, v72, v74, s62 bitop3:0x96
    v_bitop3_b32 v16, v73, v75, s62 bitop3:0x96
    v_or3_b32 v14, v14, v15, v16
    s_waitcnt vmcnt(5)
    ds_write_b64 v13, v[76:77] offset:1024
    v_bitop3_b32 v15, v76, v78, s62 bitop3:0x96
    v_bitop3_b32 v16, v77, v79, s62 bitop3:0x96
    v_or3_b32 v14, v14, v15, v16
    s_waitcnt vmcnt(4)
    ds_write_b64 v13, v[80:81] offset:1536
    v_bitop3_b32 v15, v80, v82, s62 bitop3:0x96
    v_bitop3_b32 v16, v81, v83, s62 bitop3:0x96
    v_or3_b32 v14, v14, v15, v16
    s_waitcnt vmcnt(3)
    ds_write_b64 v13, v[84:85] offset:2048
    v_bitop3_b32 v15, v84, v86, s62 bitop3:0x96
    v_bitop3_b32 v16, v85, v87, s62 bitop3:0x96
    v_or3_b32 v14, v14, v15, v16
    s_waitcnt vmcnt(2)
    ds_write_b64 v13, v[88:89] offset:2560
    v_bitop3_b32 v15, v88, v90, s62 bitop3:0x96
    v_bitop3_b32 v16, v89, v91, s62 bitop3:0x96
    v_or3_b32 v14, v14, v15, v16
    s_waitcnt vmcnt(1)
    ds_write_b64 v13, v[92:93] offset:3072
    v_bitop3_b32 v15, v92, v94, s62 bitop3:0x96
    v_bitop3_b32 v16, v93, v95, s62 bitop3:0x96
    v_or3_b32 v14, v14, v15, v16
    s_waitcnt vmcnt(0)
    ds_write_b64 v13, v[108:109] offset:3584
    v_bitop3_b32 v15, v108, v110, s62 bitop3:0x96
    v_bitop3_b32 v16, v109, v111, s62 bitop3:0x96
    v_or3_b32 v14, v14, v15, v16
    v_cmp_ne_u32 vcc, 0, v14
    s_nop 1
    s_cbranch_vccz b_kf_ok
    s_sub_u32 s63, s63, 1
    s_cbranch_scc1 b_kf_done
    buffer_load_dwordx4 v[68:71], v9, s[36:39], s53 offen offset:0 sc1
    buffer_load_dwordx4 v[72:75], v9, s[36:39], s53 offen offset:1024 sc1
    buffer_load_dwordx4 v[76:79], v9, s[36:39], s53 offen offset:2048 sc1
    buffer_load_dwordx4 v[80:83], v9, s[36:39], s53 offen offset:3072 sc1
    buffer_load_dwordx4 v[84:87], v9, s[36:39], s52 offen offset:0 sc1
    buffer_load_dwordx4 v[88:91], v9, s[36:39], s52 offen offset:1024 sc1
    buffer_load_dwordx4 v[92:95], v9, s[36:39], s52 offen offset:2048 sc1
    buffer_load_dwordx4 v[108:111], v9, s[36:39], s52 offen offset:3072 sc1
    s_branch b_kf
b_kf_ok:
    s_mov_b64 exec, 1
    ds_add_u32 v10, v11 offset:16
    s_mov_b64 exec, -1
    s_mov_b32 s46, 1
b_kf_done:
    v_lshlrev_b32 v15, 7, v1
    s_lshl_b32 s54, s26, 11
    s_add_u32 s54, s54, 131072
    s_mov_b32 s63, 40000
    s_mov_b64 exec, 65535
pf_41:
    buffer_load_dwordx4 v[16:19], v15, s[36:39], s54 offen sc1
    s_waitcnt vmcnt(0)
    v_xor_b32 v16, s62, v16
    v_xor_b32 v17, s62, v17
    v_xor_b32 v18, s62, v18
    v_xor_b32 v19, s62, v19
    v_or3_b32 v16, v16, v17, v18
    v_or_b32 v16, v16, v19
    v_cmp_ne_u32 vcc, 0, v16
    s_nop 1
    s_cbranch_vccz pfd_42
    s_sleep 4
    s_sub_u32 s63, s63, 1
    s_cmp_lg_u32 s63, 0
    s_cbranch_scc1 pf_41
pfd_42:
    s_mov_b64 exec, -1
    s_add_u32 s58, s58, 4
    s_mov_b64 exec, 1
    ds_add_u32 v10, v11 offset:4
    s_mov_b64 exec, -1
lw_43:
    ds_read_b32 v5, v10 offset:4
    s_waitcnt lgkmcnt(0)
    v_readfirstlane_b32 s51, v5
    s_nop 0
    s_cmp_ge_u32 s51, s58
    s_cbranch_scc1 lwd_44
    s_sleep 2
    s_branch lw_43
lwd_44:
    s_cmp_eq_u32 s46, 1
    s_cbranch_scc1 kfok_45
    s_lshl_b32 s53, s26, 12
    s_mov_b32 m0, s53
    s_lshr_b32 s51, s53, 12
    s_add_u32 s51, s51, s55
    s_and_b32 s51, s51, 31
    s_lshl_b32 s51, s51, 12
    buffer_load_dwordx4 v9, s[36:39], s51 offen offset:0 sc1 lds
    buffer_load_dwordx4 v9, s[36:39], s51 offen offset:1024 sc1 lds
    buffer_load_dwordx4 v9, s[36:39], s51 offen offset:2048 sc1 lds
    buffer_load_dwordx4 v9, s[36:39], s51 offen offset:3072 sc1 lds
    s_waitcnt vmcnt(0)
    s_mov_b64 exec, 1
    ds_add_u32 v10, v11 offset:16
    s_mov_b64 exec, -1
kfok_45:
lw_46:
    ds_read_b32 v5, v10 offset:96
    s_waitcnt lgkmcnt(0)
    v_readfirstlane_b32 s51, v5
    s_nop 0
    s_cmp_ge_u32 s51, 4
    s_cbranch_scc1 lwd_47
    s_sleep 1
    s_branch lw_46
lwd_47:
    s_lshl_b32 s53, s26, 12
    s_add_u32 s53, s53, 16384
    s_mov_b32 m0, s53
    s_lshr_b32 s51, s53, 12
    s_add_u32 s51, s51, s59
    s_cmp_ge_u32 s51, 32
    s_cselect_b32 s52, 28, 0
    s_sub_u32 s51, s51, s52
    s_add_u32 s51, s51, s55
    s_and_b32 s51, s51, 31
    s_lshl_b32 s51, s51, 12
    buffer_load_dwordx4 v9, s[36:39], s51 offen offset:0 sc1 lds
    buffer_load_dwordx4 v9, s[36:39], s51 offen offset:1024 sc1 lds
    buffer_load_dwordx4 v9, s[36:39], s51 offen offset:2048 sc1 lds
    buffer_load_dwordx4 v9, s[36:39], s51 offen offset:3072 sc1 lds
    s_lshl_b32 s53, s26, 12
    s_add_u32 s53, s53, 32768
    s_mov_b32 m0, s53
    s_lshr_b32 s51, s53, 12
    s_add_u32 s51, s51, s59
    s_cmp_ge_u32 s51, 32
    s_cselect_b32 s52, 28, 0
    s_sub_u32 s51, s51, s52
    s_add_u32 s51, s51, s55
    s_and_b32 s51, s51, 31
    s_lshl_b32 s51, s51, 12
    buffer_load_dwordx4 v9, s[36:39], s51 offen offset:0 sc1 lds
    buffer_load_dwordx4 v9, s[36:39], s51 offen offset:1024 sc1 lds
    buffer_load_dwordx4 v9, s[36:39], s51 offen offset:2048 sc1 lds
    buffer_load_dwordx4 v9, s[36:39], s51 offen offset:3072 sc1 lds
    s_waitcnt vmcnt(4)
    s_mov_b64 exec, 1
    ds_add_u32 v10, v11 offset:20
    s_mov_b64 exec, -1
    s_lshl_b32 s53, s26, 12
    s_add_u32 s53, s53, 49152
    s_mov_b32 m0, s53
    s_lshr_b32 s51, s53, 12
    s_add_u32 s51, s51, s59
    s_cmp_ge_u32 s51, 32
    s_cselect_b32 s52, 28, 0
    s_sub_u32 s51, s51, s52
    s_add_u32 s51, s51, s55
    s_and_b32 s51, s51, 31
    s_lshl_b32 s51, s51, 12
    buffer_load_dwordx4 v9, s[36:39], s51 offen offset:0 sc1 lds
    buffer_load_dwordx4 v9, s[36:39], s51 offen offset:1024 sc1 lds
    buffer_load_dwordx4 v9, s[36:39], s51 offen offset:2048 sc1 lds
    buffer_load_dwordx4 v9, s[36:39], s51 offen offset:3072 sc1 lds
    s_lshl_b32 s53, s26, 12
    s_add_u32 s53, s53, 65536
    s_mov_b32 m0, s53
    s_lshr_b32 s51, s53, 12
    s_add_u32 s51, s51, s59
    s_cmp_ge_u32 s51, 32
    s_cselect_b32 s52, 28, 0
    s_sub_u32 s51, s51, s52
    s_add_u32 s51, s51, s55
    s_and_b32 s51, s51, 31
    s_lshl_b32 s51, s51, 12
    buffer_load_dwordx4 v9, s[36:39], s51 offen offset:0 sc1 lds
    buffer_load_dwordx4 v9, s[36:39], s51 offen offset:1024 sc1 lds
    buffer_load_dwordx4 v9, s[36:39], s51 offen offset:2048 sc1 lds
    buffer_load_dwordx4 v9, s[36:39], s51 offen offset:3072 sc1 lds
    s_lshl_b32 s53, s26, 12
    s_add_u32 s53, s53, 81920
    s_mov_b32 m0, s53
    s_lshr_b32 s51, s53, 12
    s_add_u32 s51, s51, s59
    s_cmp_ge_u32 s51, 32
    s_cselect_b32 s52, 28, 0
    s_sub_u32 s51, s51, s52
    s_add_u32 s51, s51, s55
    s_and_b32 s51, s51, 31
    s_lshl_b32 s51, s51, 12
    buffer_load_dwordx4 v9, s[36:39], s51 offen offset:0 sc1 lds
    buffer_load_dwordx4 v9, s[36:39], s51 offen offset:1024 sc1 lds
    buffer_load_dwordx4 v9, s[36:39], s51 offen offset:2048 sc1 lds
    buffer_load_dwordx4 v9, s[36:39], s51 offen offset:3072 sc1 lds
    s_cmp_eq_u32 s43, 0
    s_cselect_b32 s4, s18, s12
    s_cselect_b32 s5, s19, s13
    s_mov_b32 s6, 0x80000
    s_mov_b32 s7, 0x20000
    s_lshr_b32 s8, s2, 3
    s_and_b32 s9, s2, 7
    s_lshl_b32 s51, s8, 14
    s_lshl_b32 s52, s9, 7
    s_add_u32 s51, s51, s52
    s_lshl_b32 s10, s26, 11
    s_add_u32 s10, s10, 98816
    s_mov_b32 m0, s10
    s_add_u32 s52, s51, 7168
    buffer_load_dwordx4 v4, s[4:7], s51 offen lds
    buffer_load_dwordx4 v4, s[4:7], s52 offen offset:1024 lds
lw_48:
    ds_read_b32 v5, v10 offset:12
    s_waitcnt lgkmcnt(0)
    v_readfirstlane_b32 s51, v5
    s_nop 0
    s_cmp_ge_u32 s51, 4
    s_cbranch_scc1 lwd_49
    s_sleep 2
    s_branch lw_48
lwd_49:
    s_mul_i32 s48, s67, 196608
    s_add_u32 s48, s48, s64
    s_add_u32 s47, s48, 24576
    s_lshl_b32 s49, s67, 7
    s_add_u32 s49, s49, s65
    s_add_u32 s66, s49, 8192
    s_add_u32 s67, s67, 1
    s_and_b32 s67, s67, 7
    s_add_u32 m0, s57, 32896
    s_nop 0
    buffer_load_dwordx4 v4, s[28:31], s49 offen lds
    s_add_u32 m0, s57, 33936
    s_nop 0
    buffer_load_dwordx4 v4, s[28:31], s66 offen lds
    s_add_u32 m0, s56, 32896
    s_nop 0
    buffer_load_dwordx4 v3, s[32:35], s48 offen offset:0 lds
    buffer_load_dwordx4 v3, s[32:35], s48 offen offset:1024 lds
    buffer_load_dwordx4 v3, s[32:35], s48 offen offset:2048 lds
    s_add_u32 m0, s56, 35968
    s_nop 0
    buffer_load_dwordx4 v3, s[32:35], s47 offen offset:0 lds
    buffer_load_dwordx4 v3, s[32:35], s47 offen offset:1024 lds
    buffer_load_dwordx4 v3, s[32:35], s47 offen offset:2048 lds
    v_bfe_u32 v14, v1, 2, 2
    v_lshlrev_b32 v14, 7, v14
    v_bfe_u32 v15, v1, 3, 1
    v_xor_b32 v15, s42, v15
    v_lshl_add_u32 v14, v15, 6, v14
    v_bfe_u32 v15, v1, 4, 1
    v_lshl_add_u32 v14, v15, 5, v14
    v_and_b32 v15, 1, v1
    v_lshl_add_u32 v14, v15, 4, v14
    v_bfe_u32 v15, v1, 1, 1
    v_lshl_add_u32 v14, v15, 3, v14
    v_lshl_add_u32 v14, v7, 9, v14
    v_add_u32 v14, s10, v14
    s_lshl_b32 s51, s9, 1
    s_add_u32 s51, s51, s42
    s_lshl_b32 s51, s51, 5
    s_add_u32 s51, s51, s8
    s_lshl_b32 s10, s51, 10
    s_lshl_b32 s51, s43, 19
    s_add_u32 s10, s10, s51
    s_add_u32 s10, s10, 14680064
    s_lshr_b32 s51, s9, 1
    s_lshl_b32 s51, s51, 5
    s_add_u32 s51, s51, s8
    s_lshl_b32 s11, s51, 7
    s_and_b32 s51, s9, 1
    s_lshl_b32 s51, s51, 2
    s_add_u32 s51, s51, s26
    s_lshl_b32 s51, s51, 2
    s_add_u32 s11, s11, s51
    s_add_u32 s11, s11, 147456
    s_waitcnt vmcnt(10)
    s_mov_b64 exec, 1
    ds_add_u32 v10, v11 offset:24
    s_mov_b64 exec, -1
    s_waitcnt vmcnt(8)
    ds_read_b64_tr_b16 v[160:161], v14 offset:0
    ds_read_b64_tr_b16 v[162:163], v14 offset:1024
    s_waitcnt vmcnt(0) lgkmcnt(0)
    buffer_store_dwordx4 v[160:163], v9, s[36:39], s10 offen sc1
    v_lshrrev_b32 v166, 1, v1
    v_lshlrev_b32 v166, 7, v166
    v_and_b32 v15, 1, v1
    v_lshl_add_u32 v166, v15, 4, v166
    s_lshl_b32 s8, s41, 12
    s_add_u32 s8, s8, 147456
    s_setprio 3
    s_mov_b32 s50, 0
    s_branch b_in
b_loop:
    v_mfma_f32_32x32x16_bf16 v[20:35], v[96:99], v[112:115], v[20:35]
    s_waitcnt vmcnt(0)
b_in:
    s_add_u32 s58, s58, 4
    s_mov_b64 exec, 1
    ds_add_u32 v10, v11 offset:4
    s_mov_b64 exec, -1
    v_mfma_f32_32x32x16_bf16 v[36:51], v[100:103], v[112:115], v[36:51]
    s_mul_i32 s48, s67, 196608
    s_add_u32 s48, s48, s64
    s_add_u32 s47, s48, 24576
    s_lshl_b32 s49, s67, 7
    s_add_u32 s49, s49, s65
    s_add_u32 s66, s49, 8192
    s_add_u32 s67, s67, 1
    s_and_b32 s67, s67, 7
lw_50:
    ds_read_b32 v5, v10 offset:4
    s_waitcnt lgkmcnt(0)
    v_readfirstlane_b32 s51, v5
    s_nop 0
    s_cmp_ge_u32 s51, s58
    s_cbranch_scc1 lwd_51
    s_branch lw_50
lwd_51:
    ds_read_b64_tr_b16 v[84:85], v8 offset:32896
    ds_read_b64_tr_b16 v[86:87], v8 offset:33408
    ds_read_b128 v[108:111], v152 offset:32896
    ds_read_b64_tr_b16 v[88:89], v8 offset:33920
    ds_read_b64_tr_b16 v[90:91], v8 offset:34432
    ds_read_b64_tr_b16 v[92:93], v8 offset:34944
    ds_read_b64_tr_b16 v[94:95], v8 offset:35456
    v_mfma_f32_32x32x16_bf16 v[52:67], v[112:115], v[104:107], v[52:67]
    s_add_u32 m0, s57, 0
    s_nop 0
    buffer_load_dwordx4 v4, s[28:31], s49 offen lds
    s_add_u32 m0, s57, 1040
    s_nop 0
    buffer_load_dwordx4 v4, s[28:31], s66 offen lds
    s_add_u32 m0, s56, 0
    s_nop 0
    buffer_load_dwordx4 v3, s[32:35], s48 offen offset:0 lds
    ds_read_b64_tr_b16 v[96:97], v8 offset:39040
    ds_read_b64_tr_b16 v[98:99], v8 offset:39552
    ds_read_b128 v[112:115], v152 offset:32928
    ds_read_b64_tr_b16 v[100:101], v8 offset:40064
    ds_read_b64_tr_b16 v[102:103], v8 offset:40576
    ds_read_b64_tr_b16 v[104:105], v8 offset:41088
    ds_read_b64_tr_b16 v[106:107], v8 offset:41600
    s_waitcnt lgkmcnt(7)
    v_mfma_f32_32x32x16_bf16 v[20:35], v[84:87], v[108:111], v[20:35]
    buffer_load_dwordx4 v3, s[32:35], s48 offen offset:1024 lds
    buffer_load_dwordx4 v3, s[32:35], s48 offen offset:2048 lds
    v_mfma_f32_32x32x16_bf16 v[36:51], v[88:91], v[108:111], v[36:51]
    s_add_u32 m0, s56, 3072
    s_nop 0
    buffer_load_dwordx4 v3, s[32:35], s47 offen offset:0 lds
    buffer_load_dwordx4 v3, s[32:35], s47 offen offset:1024 lds
    v_mfma_f32_32x32x16_bf16 v[52:67], v[108:111], v[92:95], v[52:67]
    buffer_load_dwordx4 v3, s[32:35], s47 offen offset:2048 lds
    ds_read_b64_tr_b16 v[84:85], v8 offset:45184
    ds_read_b64_tr_b16 v[86:87], v8 offset:45696
    ds_read_b128 v[108:111], v153 offset:32896
    ds_read_b64_tr_b16 v[88:89], v8 offset:46208
    ds_read_b64_tr_b16 v[90:91], v8 offset:46720
    ds_read_b64_tr_b16 v[92:93], v8 offset:47232
    ds_read_b64_tr_b16 v[94:95], v8 offset:47744
    s_waitcnt lgkmcnt(7)
    v_mfma_f32_32x32x16_bf16 v[20:35], v[96:99], v[112:115], v[20:35]
    v_mfma_f32_32x32x16_bf16 v[36:51], v[100:103], v[112:115], v[36:51]
    v_mfma_f32_32x32x16_bf16 v[52:67], v[112:115], v[104:107], v[52:67]
    ds_read_b64_tr_b16 v[96:97], v8 offset:51328
    ds_read_b64_tr_b16 v[98:99], v8 offset:51840
    ds_read_b128 v[112:115], v153 offset:32928
    ds_read_b64_tr_b16 v[100:101], v8 offset:52352
    ds_read_b64_tr_b16 v[102:103], v8 offset:52864
    ds_read_b64_tr_b16 v[104:105], v8 offset:53376
    ds_read_b64_tr_b16 v[106:107], v8 offset:53888
    s_waitcnt lgkmcnt(7)
    v_mfma_f32_32x32x16_bf16 v[20:35], v[84:87], v[108:111], v[20:35]
    v_mfma_f32_32x32x16_bf16 v[36:51], v[88:91], v[108:111], v[36:51]
    v_mfma_f32_32x32x16_bf16 v[52:67], v[108:111], v[92:95], v[52:67]
    s_waitcnt lgkmcnt(0)
    v_mfma_f32_32x32x16_bf16 v[20:35], v[96:99], v[112:115], v[20:35]
    s_waitcnt vmcnt(0)
    s_cmp_eq_u32 s50, 0
    s_cbranch_scc0 f4_52
    v_mov_b32 v164, s62
    v_mov_b32 v165, 0
    s_mov_b64 exec, 1
    buffer_store_dword v164, v165, s[36:39], s11 offen sc1
    s_mov_b64 exec, -1
f4_52:
    s_add_u32 s58, s58, 4
    s_mov_b64 exec, 1
    ds_add_u32 v10, v11 offset:4
    s_mov_b64 exec, -1
    v_mfma_f32_32x32x16_bf16 v[36:51], v[100:103], v[112:115], v[36:51]
    s_cmp_eq_u32 s50, 3
    s_cselect_b32 s64, 0x7f000000, s64
    s_cselect_b32 s65, 0x7f000000, s65
    s_cselect_b32 s56, 0x30000, s56
    s_cselect_b32 s57, 0x30000, s57
    s_mul_i32 s48, s67, 196608
    s_add_u32 s48, s48, s64
    s_add_u32 s47, s48, 24576
    s_lshl_b32 s49, s67, 7
    s_add_u32 s49, s49, s65
    s_add_u32 s66, s49, 8192
    s_add_u32 s67, s67, 1
    s_and_b32 s67, s67, 7
lw_53:
    ds_read_b32 v5, v10 offset:4
    s_waitcnt lgkmcnt(0)
    v_readfirstlane_b32 s51, v5
    s_nop 0
    s_cmp_ge_u32 s51, s58
    s_cbranch_scc1 lwd_54
    s_branch lw_53
lwd_54:
    ds_read_b64_tr_b16 v[84:85], v8 offset:0
    ds_read_b64_tr_b16 v[86:87], v8 offset:512
    ds_read_b128 v[108:111], v152 offset:0
    ds_read_b64_tr_b16 v[88:89], v8 offset:1024
    ds_read_b64_tr_b16 v[90:91], v8 offset:1536
    ds_read_b64_tr_b16 v[92:93], v8 offset:2048
    ds_read_b64_tr_b16 v[94:95], v8 offset:2560
    v_mfma_f32_32x32x16_bf16 v[52:67], v[112:115], v[104:107], v[52:67]
    s_add_u32 m0, s57, 32896
    s_nop 0
    buffer_load_dwordx4 v4, s[28:31], s49 offen lds
    s_add_u32 m0, s57, 33936
    s_nop 0
    buffer_load_dwordx4 v4, s[28:31], s66 offen lds
    s_add_u32 m0, s56, 32896
    s_nop 0
    buffer_load_dwordx4 v3, s[32:35], s48 offen offset:0 lds
    ds_read_b64_tr_b16 v[96:97], v8 offset:6144
    ds_read_b64_tr_b16 v[98:99], v8 offset:6656
    ds_read_b128 v[112:115], v152 offset:32
    ds_read_b64_tr_b16 v[100:101], v8 offset:7168
    ds_read_b64_tr_b16 v[102:103], v8 offset:7680
    ds_read_b64_tr_b16 v[104:105], v8 offset:8192
    ds_read_b64_tr_b16 v[106:107], v8 offset:8704
    s_waitcnt lgkmcnt(7)
    v_mfma_f32_32x32x16_bf16 v[20:35], v[84:87], v[108:111], v[20:35]
    buffer_load_dwordx4 v3, s[32:35], s48 offen offset:1024 lds
    buffer_load_dwordx4 v3, s[32:35], s48 offen offset:2048 lds
    v_mfma_f32_32x32x16_bf16 v[36:51], v[88:91], v[108:111], v[36:51]
    s_add_u32 m0, s56, 35968
    s_nop 0
    buffer_load_dwordx4 v3, s[32:35], s47 offen offset:0 lds
    buffer_load_dwordx4 v3, s[32:35], s47 offen offset:1024 lds
    v_mfma_f32_32x32x16_bf16 v[52:67], v[108:111], v[92:95], v[52:67]
    buffer_load_dwordx4 v3, s[32:35], s47 offen offset:2048 lds
    ds_read_b64_tr_b16 v[84:85], v8 offset:12288
    ds_read_b64_tr_b16 v[86:87], v8 offset:12800
    ds_read_b128 v[108:111], v153 offset:0
    ds_read_b64_tr_b16 v[88:89], v8 offset:13312
    ds_read_b64_tr_b16 v[90:91], v8 offset:13824
    ds_read_b64_tr_b16 v[92:93], v8 offset:14336
    ds_read_b64_tr_b16 v[94:95], v8 offset:14848
    s_waitcnt lgkmcnt(7)
    v_mfma_f32_32x32x16_bf16 v[20:35], v[96:99], v[112:115], v[20:35]
    v_mfma_f32_32x32x16_bf16 v[36:51], v[100:103], v[112:115], v[36:51]
    v_mfma_f32_32x32x16_bf16 v[52:67], v[112:115], v[104:107], v[52:67]
    ds_read_b64_tr_b16 v[96:97], v8 offset:18432
    ds_read_b64_tr_b16 v[98:99], v8 offset:18944
    ds_read_b128 v[112:115], v153 offset:32
    ds_read_b64_tr_b16 v[100:101], v8 offset:19456
    ds_read_b64_tr_b16 v[102:103], v8 offset:19968
    ds_read_b64_tr_b16 v[104:105], v8 offset:20480
    ds_read_b64_tr_b16 v[106:107], v8 offset:20992
    s_waitcnt lgkmcnt(7)
    v_mfma_f32_32x32x16_bf16 v[20:35], v[84:87], v[108:111], v[20:35]
    v_mfma_f32_32x32x16_bf16 v[36:51], v[88:91], v[108:111], v[36:51]
    v_mfma_f32_32x32x16_bf16 v[52:67], v[108:111], v[92:95], v[52:67]
    s_waitcnt lgkmcnt(0)
    s_add_u32 s50, s50, 1
    s_cmp_lt_u32 s50, 4
    s_cbranch_scc1 b_loop
b_gend:
    buffer_load_dwordx4 v[160:163], v166, s[36:39], s8 offen sc1
    s_add_u32 s58, s58, 4
    s_mov_b64 exec, 1
    ds_add_u32 v10, v11 offset:4
    s_mov_b64 exec, -1
    v_mfma_f32_32x32x16_bf16 v[20:35], v[96:99], v[112:115], v[20:35]
    v_mfma_f32_32x32x16_bf16 v[36:51], v[100:103], v[112:115], v[36:51]
    v_mfma_f32_32x32x16_bf16 v[52:67], v[112:115], v[104:107], v[52:67]
lw_55:
    ds_read_b32 v5, v10 offset:4
    s_waitcnt lgkmcnt(0)
    v_readfirstlane_b32 s51, v5
    s_nop 0
    s_cmp_ge_u32 s51, s58
    s_cbranch_scc1 lwd_56
    s_branch lw_55
lwd_56:
    s_mov_b32 s54, 94208
    s_mov_b32 m0, s54
    s_lshr_b32 s51, s54, 12
    s_add_u32 s51, s51, s59
    s_cmp_ge_u32 s51, 32
    s_cselect_b32 s52, 28, 0
    s_sub_u32 s51, s51, s52
    s_add_u32 s51, s51, s55
    s_and_b32 s51, s51, 31
    s_lshl_b32 s51, s51, 12
    buffer_load_dwordx4 v9, s[36:39], s51 offen offset:3072 sc1 lds
    s_lshl_b32 s54, s26, 13
    s_add_u32 s54, s54, 98304
    s_mov_b32 m0, s54
    s_lshr_b32 s51, s54, 12
    s_add_u32 s51, s51, s59
    s_cmp_ge_u32 s51, 32
    s_cselect_b32 s52, 28, 0
    s_sub_u32 s51, s51, s52
    s_add_u32 s51, s51, s55
    s_and_b32 s51, s51, 31
    s_lshl_b32 s51, s51, 12
    buffer_load_dwordx4 v9, s[36:39], s51 offen offset:0 sc1 lds
    buffer_load_dwordx4 v9, s[36:39], s51 offen offset:1024 sc1 lds
    buffer_load_dwordx4 v9, s[36:39], s51 offen offset:2048 sc1 lds
    buffer_load_dwordx4 v9, s[36:39], s51 offen offset:3072 sc1 lds
    s_add_u32 s54, s54, 4096
    s_mov_b32 m0, s54
    s_lshr_b32 s51, s54, 12
    s_add_u32 s51, s51, s59
    s_cmp_ge_u32 s51, 32
    s_cselect_b32 s52, 28, 0
    s_sub_u32 s51, s51, s52
    s_add_u32 s51, s51, s55
    s_and_b32 s51, s51, 31
    s_lshl_b32 s51, s51, 12
    buffer_load_dwordx4 v9, s[36:39], s51 offen offset:0 sc1 lds
    buffer_load_dwordx4 v9, s[36:39], s51 offen offset:1024 sc1 lds
    buffer_load_dwordx4 v9, s[36:39], s51 offen offset:2048 sc1 lds
    buffer_load_dwordx4 v9, s[36:39], s51 offen offset:3072 sc1 lds
    v_cvt_pk_bf16_f32 v92, v36, v37
    v_cvt_pk_bf16_f32 v93, v38, v39
    v_cvt_pk_bf16_f32 v94, v40, v41
    v_cvt_pk_bf16_f32 v95, v42, v43
    v_cvt_pk_bf16_f32 v96, v44, v45
    v_cvt_pk_bf16_f32 v97, v46, v47
    v_cvt_pk_bf16_f32 v98, v48, v49
    v_cvt_pk_bf16_f32 v99, v50, v51
    v_cvt_pk_bf16_f32 v100, v52, v53
    v_cvt_pk_bf16_f32 v101, v54, v55
    v_cvt_pk_bf16_f32 v102, v56, v57
    v_cvt_pk_bf16_f32 v103, v58, v59
    v_cvt_pk_bf16_f32 v104, v60, v61
    v_cvt_pk_bf16_f32 v105, v62, v63
    v_cvt_pk_bf16_f32 v106, v64, v65
    v_cvt_pk_bf16_f32 v107, v66, v67
    s_mul_i32 s51, s42, 3072
    s_add_u32 s51, s51, 155648
    v_add_u32 v13, s51, v9
    s_lshl_b32 s52, s44, 3
    s_add_u32 s52, s52, s45
    s_lshl_b32 s53, s52, 1
    s_add_u32 s53, s53, s42
    s_mul_i32 s53, s53, 3072
    s_add_u32 s53, s53, 5242880
    s_lshl_b32 s52, s52, 7
    s_lshl_b32 s51, s42, 2
    s_add_u32 s52, s52, s51
    s_add_u32 s52, s52, 163840
    s_cmp_eq_u32 s43, 0
    s_cbranch_scc0 b_w1_57
    ds_write_b128 v13, v[92:95]
    ds_write_b128 v13, v[96:99] offset:1024
    ds_write_b128 v13, v[104:107] offset:2048
    s_waitcnt vmcnt(0)
    s_branch b_w2_58
b_w1_57:
    buffer_store_dwordx4 v[92:95], v9, s[36:39], s53 offen sc1
    buffer_store_dwordx4 v[96:99], v9, s[36:39], s53 offen offset:1024 sc1
    buffer_store_dwordx4 v[104:107], v9, s[36:39], s53 offen offset:2048 sc1
    s_waitcnt vmcnt(0)
    v_mov_b32 v14, s62
    v_mov_b32 v15, 0
    s_mov_b64 exec, 1
    buffer_store_dword v14, v15, s[36:39], s52 offen sc1
    s_mov_b64 exec, -1
b_w2_58:
    v_cvt_pk_bf16_f32 v84, v20, v21
    v_cvt_pk_bf16_f32 v85, v22, v23
    v_cvt_pk_bf16_f32 v86, v24, v25
    v_cvt_pk_bf16_f32 v87, v26, v27
    v_cvt_pk_bf16_f32 v88, v28, v29
    v_cvt_pk_bf16_f32 v89, v30, v31
    v_cvt_pk_bf16_f32 v90, v32, v33
    v_cvt_pk_bf16_f32 v91, v34, v35
    s_waitcnt vmcnt(1)
    s_mov_b64 exec, 1
    ds_add_u32 v10, v11 offset:28
    s_mov_b64 exec, -1
    s_add_u32 s58, s58, 4
    s_mov_b64 exec, 1
    ds_add_u32 v10, v11 offset:4
    s_mov_b64 exec, -1
lw_59:
    ds_read_b32 v5, v10 offset:4
    s_waitcnt lgkmcnt(0)
    v_readfirstlane_b32 s51, v5
    s_nop 0
    s_cmp_ge_u32 s51, s58
    s_cbranch_scc1 lwd_60
    s_sleep 2
    s_branch lw_59
lwd_60:
    s_or_b32 s51, s44, 0
    s_cselect_b32 s51, s43, 1
    s_cmp_eq_u32 s51, 0
    s_cbranch_scc0 b_x1_61
    s_sub_u32 s52, s52, 1024
    s_sub_u32 s53, s53, 49152
    v_mov_b32 v5, 0
    s_mov_b32 s63, 40000
    s_mov_b64 exec, 1
pf_63:
    buffer_load_dword v14, v5, s[36:39], s52 offen sc1
    s_waitcnt vmcnt(0)
    v_xor_b32 v14, s62, v14
    v_cmp_ne_u32 vcc, 0, v14
    s_nop 1
    s_cbranch_vccz pfd_64
    s_sleep 6
    s_sub_u32 s63, s63, 1
    s_cmp_lg_u32 s63, 0
    s_cbranch_scc1 pf_63
pfd_64:
    s_mov_b64 exec, -1
    buffer_load_dwordx4 v[108:111], v9, s[36:39], s53 offen sc1
    buffer_load_dwordx4 v[112:115], v9, s[36:39], s53 offen offset:1024 sc1
    buffer_load_dwordx4 v[116:119], v9, s[36:39], s53 offen offset:2048 sc1
    s_waitcnt vmcnt(0)
    s_branch b_x2_62
b_x1_61:
    ds_read_b128 v[108:111], v13
    ds_read_b128 v[112:115], v13 offset:1024
    ds_read_b128 v[116:119], v13 offset:2048
b_x2_62:
    s_and_b32 s51, s40, 1
    s_cmp_eq_u32 s51, s43
    s_cbranch_scc0 nosn_65
    s_lshl_b32 s51, s40, 2
    s_add_u32 s51, s51, s41
    s_lshl_b32 s51, s51, 1
    s_add_u32 s51, s51, s42
    s_lshl_b32 s51, s51, 12
    s_add_u32 s51, s51, 1048576
    v_mov_b32 v120, -1
    v_mov_b32 v121, -1
    v_mov_b32 v122, -1
    v_mov_b32 v123, -1
    buffer_store_dwordx4 v[120:123], v9, s[36:39], s51 offen offset:0 sc1
    buffer_store_dwordx4 v[120:123], v9, s[36:39], s51 offen offset:1024 sc1
    buffer_store_dwordx4 v[120:123], v9, s[36:39], s51 offen offset:2048 sc1
    buffer_store_dwordx4 v[120:123], v9, s[36:39], s51 offen offset:3072 sc1
    s_add_u32 s51, s51, 9437184
    buffer_store_dwordx4 v[120:123], v9, s[36:39], s51 offen offset:0 sc1
    buffer_store_dwordx4 v[120:123], v9, s[36:39], s51 offen offset:1024 sc1
    buffer_store_dwordx4 v[120:123], v9, s[36:39], s51 offen offset:2048 sc1
    buffer_store_dwordx4 v[120:123], v9, s[36:39], s51 offen offset:3072 sc1
nosn_65:
    s_lshl_b32 s52, s44, 1
    s_add_u32 s52, s52, s43
    s_lshl_b32 s55, s52, 4
    s_lshl_b32 s53, s45, 1
    s_add_u32 s53, s53, s42
    s_add_u32 s55, s55, s53
    s_lshl_b32 s55, s55, 11
    s_add_u32 s55, s55, 3145728
    s_lshl_b32 s57, s52, 9
    s_lshr_b32 s51, s53, 2
    s_lshl_b32 s51, s51, 7
    s_add_u32 s57, s57, s51
    s_and_b32 s51, s53, 3
    s_lshl_b32 s51, s51, 2
    s_add_u32 s57, s57, s51
    s_add_u32 s57, s57, 196608
    s_waitcnt lgkmcnt(0)
    s_mov_b32 s46, 1052289595
    s_or_b32 s60, s44, s43
    v_mfma_f32_32x32x16_bf16 v[20:35], v[92:95], v[84:87], 0
    v_mfma_f32_32x32x16_bf16 v[36:51], v[108:111], v[84:87], 0
    v_mfma_f32_32x32x16_bf16 v[52:67], v[96:99], v[88:91], 0
    v_mfma_f32_32x32x16_bf16 v[68:83], v[112:115], v[88:91], 0
    s_cmp_eq_u32 s60, 0
    s_cbranch_scc0 fz_66
    s_nop 7
    v_mov_b32 v44, 0xff800000
    v_mov_b32 v45, 0xff800000
    v_mov_b32 v46, 0xff800000
    v_mov_b32 v47, 0xff800000
    v_mov_b32 v48, 0xff800000
    v_mov_b32 v49, 0xff800000
    v_mov_b32 v50, 0xff800000
    v_mov_b32 v51, 0xff800000
    v_mov_b32 v76, 0xff800000
    v_mov_b32 v77, 0xff800000
    v_mov_b32 v78, 0xff800000
    v_mov_b32 v79, 0xff800000
    v_mov_b32 v80, 0xff800000
    v_mov_b32 v81, 0xff800000
    v_mov_b32 v82, 0xff800000
    v_mov_b32 v83, 0xff800000
fz_66:
    s_nop 7
    ds_write_b128 v126, v[44:47] offset:0
    ds_write_b128 v126, v[48:51] offset:1024
    s_nop 4
    ds_write_b128 v126, v[20:23] offset:2048
    ds_write_b128 v126, v[24:27] offset:3072
    ds_write_b128 v126, v[28:31] offset:4096
    ds_write_b128 v126, v[32:35] offset:5120
    ds_read_b32 v136, v144
    ds_read_b32 v137, v145
    ds_read_b32 v138, v146
    ds_read_b32 v139, v147
    ds_write_b128 v126, v[76:79] offset:0
    ds_write_b128 v126, v[80:83] offset:1024
    ds_write_b128 v126, v[52:55] offset:2048
    ds_write_b128 v126, v[56:59] offset:3072
    ds_write_b128 v126, v[60:63] offset:4096
    ds_write_b128 v126, v[64:67] offset:5120
    ds_read_b32 v140, v144
    ds_read_b32 v141, v145
    ds_read_b32 v142, v146
    ds_read_b32 v143, v147
    ds_write_b128 v126, v[132:135] offset:0
    ds_write_b128 v126, v[132:135] offset:1024
    ds_write_b128 v126, v[132:135] offset:2048
    ds_write_b128 v126, v[132:135] offset:3072
    ds_write_b128 v126, v[132:135] offset:4096
    ds_write_b128 v126, v[132:135] offset:5120
    s_waitcnt lgkmcnt(15)
    s_waitcnt lgkmcnt(6)
    v_max3_f32 v152, v136, v137, v138
    v_max_f32 v152, v152, v139
    v_mov_b32 v153, v152
    s_nop 1
    v_permlane32_swap_b32 v152, v153
    v_max_f32 v152, v152, v153
    v_mul_f32 v152, s46, v152
    v_fma_f32 v136, v136, s46, -v152
    v_fma_f32 v137, v137, s46, -v152
    v_fma_f32 v138, v138, s46, -v152
    v_fma_f32 v139, v139, s46, -v152
    v_exp_f32 v136, v136
    v_exp_f32 v137, v137
    v_exp_f32 v138, v138
    v_exp_f32 v139, v139
    v_add_f32 v152, v136, v137
    v_add_f32 v153, v138, v139
    v_add_f32 v152, v152, v153
    v_mov_b32 v153, v152
    s_nop 1
    v_permlane32_swap_b32 v152, v153
    v_add_f32 v152, v152, v153
    v_rcp_f32 v152, v152
    s_nop 0
    v_mul_f32 v136, v136, v152
    v_mul_f32 v137, v137, v152
    v_mul_f32 v138, v138, v152
    v_mul_f32 v139, v139, v152
    v_cvt_pk_bf16_f32 v154, v136, v137
    v_cvt_pk_bf16_f32 v155, v138, v139
    ds_write_b16 v128, v154 offset:0
    ds_write_b16_d16_hi v129, v154 offset:0
    ds_write_b16 v130, v155 offset:0
    ds_write_b16_d16_hi v131, v155 offset:0
    s_waitcnt lgkmcnt(4)
    v_max3_f32 v156, v140, v141, v142
    v_max_f32 v156, v156, v143
    v_mov_b32 v157, v156
    s_nop 1
    v_permlane32_swap_b32 v156, v157
    v_max_f32 v156, v156, v157
    v_mul_f32 v156, s46, v156
    v_fma_f32 v140, v140, s46, -v156
    v_fma_f32 v141, v141, s46, -v156
    v_fma_f32 v142, v142, s46, -v156
    v_fma_f32 v143, v143, s46, -v156
    v_exp_f32 v140, v140
    v_exp_f32 v141, v141
    v_exp_f32 v142, v142
    v_exp_f32 v143, v143
    v_add_f32 v156, v140, v141
    v_add_f32 v157, v142, v143
    v_add_f32 v156, v156, v157
    v_mov_b32 v157, v156
    s_nop 1
    v_permlane32_swap_b32 v156, v157
    v_add_f32 v156, v156, v157
    v_rcp_f32 v156, v156
    s_nop 0
    v_mul_f32 v140, v140, v156
    v_mul_f32 v141, v141, v156
    v_mul_f32 v142, v142, v156
    v_mul_f32 v143, v143, v156
    v_cvt_pk_bf16_f32 v158, v140, v141
    v_cvt_pk_bf16_f32 v159, v142, v143
    ds_write_b16 v128, v158 offset:3072
    ds_write_b16_d16_hi v129, v158 offset:3072
    ds_write_b16 v130, v159 offset:3072
    ds_write_b16_d16_hi v131, v159 offset:3072
    ds_read_b128 v[20:23], v126 offset:0
    ds_read_b128 v[24:27], v126 offset:1024
    ds_read_b128 v[28:31], v126 offset:2048
    ds_read_b128 v[32:35], v126 offset:3072
    ds_read_b128 v[36:39], v126 offset:4096
    ds_read_b128 v[40:43], v126 offset:5120
    s_waitcnt lgkmcnt(3)
    v_mfma_f32_32x32x16_bf16 v[52:67], v[116:119], v[20:23], 0
    v_mfma_f32_32x32x16_bf16 v[52:67], v[100:103], v[24:27], v[52:67]
    v_mfma_f32_32x32x16_bf16 v[52:67], v[104:107], v[28:31], v[52:67]
    s_waitcnt lgkmcnt(0)
    v_mfma_f32_32x32x16_bf16 v[68:83], v[116:119], v[32:35], 0
    v_mfma_f32_32x32x16_bf16 v[68:83], v[100:103], v[36:39], v[68:83]
    v_mfma_f32_32x32x16_bf16 v[68:83], v[104:107], v[40:43], v[68:83]
    s_nop 7
    v_cvt_pk_bf16_f32 v136, v52, v53
    v_cvt_pk_bf16_f32 v137, v54, v55
    v_cvt_pk_bf16_f32 v138, v56, v57
    v_cvt_pk_bf16_f32 v139, v58, v59
    buffer_store_dwordx4 v[136:139], v9, s[36:39], s55 offen offset:0 sc1
    v_cvt_pk_bf16_f32 v140, v76, v77
    v_cvt_pk_bf16_f32 v141, v78, v79
    v_cvt_pk_bf16_f32 v142, v80, v81
    v_cvt_pk_bf16_f32 v143, v82, v83
    buffer_store_dwordx4 v[140:143], v9, s[36:39], s55 offen offset:1024 sc1
    s_waitcnt vmcnt(0)
    s_getreg_b32 s61, hwreg(HW_REG_XCC_ID, 0, 4)
    s_xor_b32 s62, s62, s61
    v_mov_b32 v12, s62
    v_mov_b32 v13, 0
    s_mov_b64 exec, 1
    buffer_store_dword v12, v13, s[36:39], s57 offen sc1
    s_mov_b64 exec, -1
    s_xor_b32 s62, s62, s61
    s_mov_b32 s28, s20
    s_mov_b32 s29, s21
    s_mov_b32 s30, 4194304
    s_mov_b32 s31, 0x20000
    s_lshl_b32 s47, s41, 8
    s_lshl_b32 s51, s26, 6
    s_add_u32 s47, s47, s51
    s_lshl_b32 s64, s47, 9
    s_add_u32 s64, s64, 14680064
    v_lshrrev_b32 v8, 2, v1
    v_and_b32 v3, 3, v1
    v_lshlrev_b32 v4, 11, v8
    v_lshl_add_u32 v4, v3, 4, v4
    s_mul_i32 s51, s26, 6144
    s_add_u32 s51, s51, 131072
    v_mul_u32_u24 v8, 80, v8
    v_lshl_add_u32 v3, v3, 4, v8
    v_add_u32 v3, s51, v3
    v_mul_u32_u24 v8, 80, v6
    v_lshl_add_u32 v8, v7, 4, v8
    v_add_u32 v8, s51, v8
    s_lshl_b32 s51, s40, 16
    s_add_u32 s47, s47, s51
    s_add_u32 s56, s47, 32768
    v_xor_b32 v160, s62, v160
    v_xor_b32 v161, s62, v161
    v_xor_b32 v162, s62, v162
    v_xor_b32 v163, s62, v163
    v_or3_b32 v160, v160, v161, v162
    v_or_b32 v160, v160, v163
    v_cmp_ne_u32 vcc, 0, v160
    s_nop 1
    s_cbranch_vccz f4ok_67
    s_mov_b32 s63, 40000
pf_68:
    buffer_load_dwordx4 v[160:163], v166, s[36:39], s8 offen sc1
    s_waitcnt vmcnt(0)
    v_xor_b32 v160, s62, v160
    v_xor_b32 v161, s62, v161
    v_xor_b32 v162, s62, v162
    v_xor_b32 v163, s62, v163
    v_or3_b32 v160, v160, v161, v162
    v_or_b32 v160, v160, v163
    v_cmp_ne_u32 vcc, 0, v160
    s_nop 1
    s_cbranch_vccz pfd_69
    s_sleep 8
    s_sub_u32 s63, s63, 1
    s_cmp_lg_u32 s63, 0
    s_cbranch_scc1 pf_68
pfd_69:
    s_mov_b64 exec, -1
f4ok_67:
    s_bfe_u32 s9, s3, 0x30002
    s_lshl_b32 s9, s9, 12
    s_add_u32 s51, s9, 0
    s_and_b32 s51, s51, 0x7fff
    s_add_u32 s48, s64, s51
    buffer_load_dwordx4 v[40:43], v9, s[36:39], s48 offen offset:0 sc1
    buffer_load_dwordx4 v[44:47], v9, s[36:39], s48 offen offset:1024 sc1
    buffer_load_dwordx4 v[48:51], v9, s[36:39], s48 offen offset:2048 sc1
    buffer_load_dwordx4 v[52:55], v9, s[36:39], s48 offen offset:3072 sc1
    s_add_u32 s51, s9, 4096
    s_and_b32 s51, s51, 0x7fff
    s_add_u32 s48, s64, s51
    buffer_load_dwordx4 v[56:59], v9, s[36:39], s48 offen offset:0 sc1
    buffer_load_dwordx4 v[60:63], v9, s[36:39], s48 offen offset:1024 sc1
    buffer_load_dwordx4 v[64:67], v9, s[36:39], s48 offen offset:2048 sc1
    buffer_load_dwordx4 v[68:71], v9, s[36:39], s48 offen offset:3072 sc1
    s_add_u32 s51, s9, 8192
    s_and_b32 s51, s51, 0x7fff
    s_add_u32 s48, s64, s51
    buffer_load_dwordx4 v[72:75], v9, s[36:39], s48 offen offset:0 sc1
    buffer_load_dwordx4 v[76:79], v9, s[36:39], s48 offen offset:1024 sc1
    buffer_load_dwordx4 v[80:83], v9, s[36:39], s48 offen offset:2048 sc1
    buffer_load_dwordx4 v[84:87], v9, s[36:39], s48 offen offset:3072 sc1
    s_add_u32 s51, s9, 12288
    s_and_b32 s51, s51, 0x7fff
    s_add_u32 s48, s64, s51
    buffer_load_dwordx4 v[88:91], v9, s[36:39], s48 offen offset:0 sc1
    buffer_load_dwordx4 v[92:95], v9, s[36:39], s48 offen offset:1024 sc1
    buffer_load_dwordx4 v[96:99], v9, s[36:39], s48 offen offset:2048 sc1
    buffer_load_dwordx4 v[100:103], v9, s[36:39], s48 offen offset:3072 sc1
    s_add_u32 s51, s9, 16384
    s_and_b32 s51, s51, 0x7fff
    s_add_u32 s48, s64, s51
    buffer_load_dwordx4 v[104:107], v9, s[36:39], s48 offen offset:0 sc1
    buffer_load_dwordx4 v[108:111], v9, s[36:39], s48 offen offset:1024 sc1
    buffer_load_dwordx4 v[112:115], v9, s[36:39], s48 offen offset:2048 sc1
    buffer_load_dwordx4 v[116:119], v9, s[36:39], s48 offen offset:3072 sc1
    s_add_u32 s51, s9, 20480
    s_and_b32 s51, s51, 0x7fff
    s_add_u32 s48, s64, s51
    buffer_load_dwordx4 v[120:123], v9, s[36:39], s48 offen offset:0 sc1
    buffer_load_dwordx4 v[124:127], v9, s[36:39], s48 offen offset:1024 sc1
    buffer_load_dwordx4 v[128:131], v9, s[36:39], s48 offen offset:2048 sc1
    buffer_load_dwordx4 v[132:135], v9, s[36:39], s48 offen offset:3072 sc1
    s_add_u32 s51, s9, 24576
    s_and_b32 s51, s51, 0x7fff
    s_add_u32 s48, s64, s51
    buffer_load_dwordx4 v[136:139], v9, s[36:39], s48 offen offset:0 sc1
    buffer_load_dwordx4 v[140:143], v9, s[36:39], s48 offen offset:1024 sc1
    buffer_load_dwordx4 v[144:147], v9, s[36:39], s48 offen offset:2048 sc1
    buffer_load_dwordx4 v[148:151], v9, s[36:39], s48 offen offset:3072 sc1
    s_add_u32 s51, s9, 28672
    s_and_b32 s51, s51, 0x7fff
    s_add_u32 s48, s64, s51
    buffer_load_dwordx4 v[152:155], v9, s[36:39], s48 offen offset:0 sc1
    buffer_load_dwordx4 v[156:159], v9, s[36:39], s48 offen offset:1024 sc1
    buffer_load_dwordx4 v[160:163], v9, s[36:39], s48 offen offset:2048 sc1
    buffer_load_dwordx4 v[164:167], v9, s[36:39], s48 offen offset:3072 sc1
    v_lshlrev_b32 v5, 7, v1
    s_lshl_b32 s57, s40, 9
    s_add_u32 s57, s57, 196608
    s_mov_b32 s63, 40000
    s_xor_b32 s51, s62, s61
    s_mov_b64 exec, 15
b_f3:
    buffer_load_dwordx4 v[28:31], v5, s[36:39], s57 offen sc1
    s_waitcnt vmcnt(0)
    v_xor_b32 v28, s51, v28
    v_xor_b32 v29, s51, v29
    v_xor_b32 v30, s51, v30
    v_xor_b32 v31, s51, v31
    v_or3_b32 v28, v28, v29, v30
    v_or_b32 v28, v28, v31
    v_cmp_lt_u32 vcc, 15, v28
    s_nop 1
    s_cbranch_vccz b_f3d
    s_sleep 8
    s_sub_u32 s63, s63, 1
    s_cmp_lg_u32 s63, 0
    s_cbranch_scc1 b_f3
b_f3d:
    v_cmp_ne_u32 vcc, 0, v28
    s_mov_b64 exec, -1
    s_cbranch_vccz b_f3l
    s_mov_b64 exec, 1
    ds_add_u32 v10, v11 offset:160
    s_mov_b64 exec, -1
b_f3l:
    s_mov_b64 exec, 1
    ds_add_u32 v10, v11 offset:32
    s_mov_b64 exec, -1
lw_70:
    ds_read_b32 v5, v10 offset:104
    s_waitcnt lgkmcnt(0)
    v_readfirstlane_b32 s51, v5
    s_nop 0
    s_cmp_ge_u32 s51, 8
    s_cbranch_scc1 lwd_71
    s_sleep 8
    s_branch lw_70
lwd_71:
    s_lshl_b32 s49, s40, 15
    s_add_u32 s49, s49, 3145728
    s_lshl_b32 s52, s26, 13
    s_add_u32 s46, s52, 24576
    s_add_u32 s52, s52, s9
    s_add_u32 m0, s46, 0
    s_add_u32 s51, s52, 0
    s_and_b32 s51, s51, 0x7fff
    s_add_u32 s51, s51, s49
    buffer_load_dwordx4 v9, s[36:39], s51 offen offset:0 sc1 lds
    buffer_load_dwordx4 v9, s[36:39], s51 offen offset:1024 sc1 lds
    buffer_load_dwordx4 v9, s[36:39], s51 offen offset:2048 sc1 lds
    buffer_load_dwordx4 v9, s[36:39], s51 offen offset:3072 sc1 lds
    s_add_u32 m0, s46, 4096
    s_add_u32 s51, s52, 4096
    s_and_b32 s51, s51, 0x7fff
    s_add_u32 s51, s51, s49
    buffer_load_dwordx4 v9, s[36:39], s51 offen offset:0 sc1 lds
    buffer_load_dwordx4 v9, s[36:39], s51 offen offset:1024 sc1 lds
    buffer_load_dwordx4 v9, s[36:39], s51 offen offset:2048 sc1 lds
    buffer_load_dwordx4 v9, s[36:39], s51 offen offset:3072 sc1 lds
    v_add_u32 v0, 24576, v9
    s_add_u32 s64, s64, 0x80000
    s_lshl_b32 s10, s41, 13
    s_waitcnt vmcnt(0)
    s_add_u32 s58, s58, 4
    s_mov_b64 exec, 1
    ds_add_u32 v10, v11 offset:4
    s_mov_b64 exec, -1
lw_72:
    ds_read_b32 v5, v10 offset:4
    s_waitcnt lgkmcnt(0)
    v_readfirstlane_b32 s51, v5
    s_nop 0
    s_cmp_ge_u32 s51, s58
    s_cbranch_scc1 lwd_73
    s_sleep 2
    s_branch lw_72
lwd_73:
    ds_read_b128 v[28:31], v0 offset:0
    ds_read_b128 v[32:35], v0 offset:1024
    ds_read_b128 v[36:39], v0 offset:2048
    s_waitcnt lgkmcnt(2)
    v_mfma_f32_32x32x16_bf16 v[12:27], v[40:43], v[28:31], 0
    s_add_u32 s51, s10, 0
    s_and_b32 s51, s51, 0x7fff
    s_add_u32 s48, s64, s51
    buffer_load_dwordx4 v[40:43], v9, s[36:39], s48 offen offset:0 sc1
    ds_read_b128 v[28:31], v0 offset:3072
    s_waitcnt lgkmcnt(2)
    v_mfma_f32_32x32x16_bf16 v[12:27], v[44:47], v[32:35], v[12:27]
    buffer_load_dwordx4 v[44:47], v9, s[36:39], s48 offen offset:1024 sc1
    ds_read_b128 v[32:35], v0 offset:4096
    s_waitcnt lgkmcnt(2)
    v_mfma_f32_32x32x16_bf16 v[12:27], v[48:51], v[36:39], v[12:27]
    buffer_load_dwordx4 v[48:51], v9, s[36:39], s48 offen offset:2048 sc1
    ds_read_b128 v[36:39], v0 offset:5120
    s_waitcnt lgkmcnt(2)
    v_mfma_f32_32x32x16_bf16 v[12:27], v[52:55], v[28:31], v[12:27]
    buffer_load_dwordx4 v[52:55], v9, s[36:39], s48 offen offset:3072 sc1
    ds_read_b128 v[28:31], v0 offset:6144
    s_waitcnt lgkmcnt(2)
    v_mfma_f32_32x32x16_bf16 v[12:27], v[56:59], v[32:35], v[12:27]
    s_add_u32 s51, s10, 4096
    s_and_b32 s51, s51, 0x7fff
    s_add_u32 s48, s64, s51
    buffer_load_dwordx4 v[56:59], v9, s[36:39], s48 offen offset:0 sc1
    ds_read_b128 v[32:35], v0 offset:7168
    s_waitcnt lgkmcnt(2)
    v_mfma_f32_32x32x16_bf16 v[12:27], v[60:63], v[36:39], v[12:27]
    buffer_load_dwordx4 v[60:63], v9, s[36:39], s48 offen offset:1024 sc1
    ds_read_b128 v[36:39], v0 offset:8192
    s_waitcnt lgkmcnt(2)
    v_mfma_f32_32x32x16_bf16 v[12:27], v[64:67], v[28:31], v[12:27]
    buffer_load_dwordx4 v[64:67], v9, s[36:39], s48 offen offset:2048 sc1
    ds_read_b128 v[28:31], v0 offset:9216
    s_waitcnt lgkmcnt(2)
    v_mfma_f32_32x32x16_bf16 v[12:27], v[68:71], v[32:35], v[12:27]
    buffer_load_dwordx4 v[68:71], v9, s[36:39], s48 offen offset:3072 sc1
    ds_read_b128 v[32:35], v0 offset:10240
    s_waitcnt lgkmcnt(2)
    v_mfma_f32_32x32x16_bf16 v[12:27], v[72:75], v[36:39], v[12:27]
    s_add_u32 s51, s10, 8192
    s_and_b32 s51, s51, 0x7fff
    s_add_u32 s48, s64, s51
    buffer_load_dwordx4 v[72:75], v9, s[36:39], s48 offen offset:0 sc1
    ds_read_b128 v[36:39], v0 offset:11264
    s_waitcnt lgkmcnt(2)
    v_mfma_f32_32x32x16_bf16 v[12:27], v[76:79], v[28:31], v[12:27]
    buffer_load_dwordx4 v[76:79], v9, s[36:39], s48 offen offset:1024 sc1
    ds_read_b128 v[28:31], v0 offset:12288
    s_waitcnt lgkmcnt(2)
    v_mfma_f32_32x32x16_bf16 v[12:27], v[80:83], v[32:35], v[12:27]
    buffer_load_dwordx4 v[80:83], v9, s[36:39], s48 offen offset:2048 sc1
    ds_read_b128 v[32:35], v0 offset:13312
    s_waitcnt lgkmcnt(2)
    v_mfma_f32_32x32x16_bf16 v[12:27], v[84:87], v[36:39], v[12:27]
    buffer_load_dwordx4 v[84:87], v9, s[36:39], s48 offen offset:3072 sc1
    ds_read_b128 v[36:39], v0 offset:14336
    s_waitcnt lgkmcnt(2)
    v_mfma_f32_32x32x16_bf16 v[12:27], v[88:91], v[28:31], v[12:27]
    s_add_u32 s51, s10, 12288
    s_and_b32 s51, s51, 0x7fff
    s_add_u32 s48, s64, s51
    buffer_load_dwordx4 v[88:91], v9, s[36:39], s48 offen offset:0 sc1
    ds_read_b128 v[28:31], v0 offset:15360
    s_waitcnt lgkmcnt(2)
    v_mfma_f32_32x32x16_bf16 v[12:27], v[92:95], v[32:35], v[12:27]
    buffer_load_dwordx4 v[92:95], v9, s[36:39], s48 offen offset:1024 sc1
    ds_read_b128 v[32:35], v0 offset:16384
    s_waitcnt lgkmcnt(2)
    v_mfma_f32_32x32x16_bf16 v[12:27], v[96:99], v[36:39], v[12:27]
    buffer_load_dwordx4 v[96:99], v9, s[36:39], s48 offen offset:2048 sc1
    ds_read_b128 v[36:39], v0 offset:17408
    s_waitcnt lgkmcnt(2)
    v_mfma_f32_32x32x16_bf16 v[12:27], v[100:103], v[28:31], v[12:27]
    buffer_load_dwordx4 v[100:103], v9, s[36:39], s48 offen offset:3072 sc1
    ds_read_b128 v[28:31], v0 offset:18432
    s_waitcnt lgkmcnt(2)
    v_mfma_f32_32x32x16_bf16 v[12:27], v[104:107], v[32:35], v[12:27]
    s_add_u32 s51, s10, 16384
    s_and_b32 s51, s51, 0x7fff
    s_add_u32 s48, s64, s51
    buffer_load_dwordx4 v[104:107], v9, s[36:39], s48 offen offset:0 sc1
    ds_read_b128 v[32:35], v0 offset:19456
    s_waitcnt lgkmcnt(2)
    v_mfma_f32_32x32x16_bf16 v[12:27], v[108:111], v[36:39], v[12:27]
    buffer_load_dwordx4 v[108:111], v9, s[36:39], s48 offen offset:1024 sc1
    ds_read_b128 v[36:39], v0 offset:20480
    s_waitcnt lgkmcnt(2)
    v_mfma_f32_32x32x16_bf16 v[12:27], v[112:115], v[28:31], v[12:27]
    buffer_load_dwordx4 v[112:115], v9, s[36:39], s48 offen offset:2048 sc1
    ds_read_b128 v[28:31], v0 offset:21504
    s_waitcnt lgkmcnt(2)
    v_mfma_f32_32x32x16_bf16 v[12:27], v[116:119], v[32:35], v[12:27]
    buffer_load_dwordx4 v[116:119], v9, s[36:39], s48 offen offset:3072 sc1
    ds_read_b128 v[32:35], v0 offset:22528
    s_waitcnt lgkmcnt(2)
    v_mfma_f32_32x32x16_bf16 v[12:27], v[120:123], v[36:39], v[12:27]
    s_add_u32 s51, s10, 20480
    s_and_b32 s51, s51, 0x7fff
    s_add_u32 s48, s64, s51
    buffer_load_dwordx4 v[120:123], v9, s[36:39], s48 offen offset:0 sc1
    ds_read_b128 v[36:39], v0 offset:23552
    s_waitcnt lgkmcnt(2)
    v_mfma_f32_32x32x16_bf16 v[12:27], v[124:127], v[28:31], v[12:27]
    buffer_load_dwordx4 v[124:127], v9, s[36:39], s48 offen offset:1024 sc1
    ds_read_b128 v[28:31], v0 offset:24576
    s_waitcnt lgkmcnt(2)
    v_mfma_f32_32x32x16_bf16 v[12:27], v[128:131], v[32:35], v[12:27]
    buffer_load_dwordx4 v[128:131], v9, s[36:39], s48 offen offset:2048 sc1
    ds_read_b128 v[32:35], v0 offset:25600
    s_waitcnt lgkmcnt(2)
    v_mfma_f32_32x32x16_bf16 v[12:27], v[132:135], v[36:39], v[12:27]
    buffer_load_dwordx4 v[132:135], v9, s[36:39], s48 offen offset:3072 sc1
    ds_read_b128 v[36:39], v0 offset:26624
    s_waitcnt lgkmcnt(2)
    v_mfma_f32_32x32x16_bf16 v[12:27], v[136:139], v[28:31], v[12:27]
    s_add_u32 s51, s10, 24576
    s_and_b32 s51, s51, 0x7fff
    s_add_u32 s48, s64, s51
    buffer_load_dwordx4 v[136:139], v9, s[36:39], s48 offen offset:0 sc1
    ds_read_b128 v[28:31], v0 offset:27648
    s_waitcnt lgkmcnt(2)
    v_mfma_f32_32x32x16_bf16 v[12:27], v[140:143], v[32:35], v[12:27]
    buffer_load_dwordx4 v[140:143], v9, s[36:39], s48 offen offset:1024 sc1
    ds_read_b128 v[32:35], v0 offset:28672
    s_waitcnt lgkmcnt(2)
    v_mfma_f32_32x32x16_bf16 v[12:27], v[144:147], v[36:39], v[12:27]
    buffer_load_dwordx4 v[144:147], v9, s[36:39], s48 offen offset:2048 sc1
    ds_read_b128 v[36:39], v0 offset:29696
    s_waitcnt lgkmcnt(2)
    v_mfma_f32_32x32x16_bf16 v[12:27], v[148:151], v[28:31], v[12:27]
    buffer_load_dwordx4 v[148:151], v9, s[36:39], s48 offen offset:3072 sc1
    ds_read_b128 v[28:31], v0 offset:30720
    s_waitcnt lgkmcnt(2)
    v_mfma_f32_32x32x16_bf16 v[12:27], v[152:155], v[32:35], v[12:27]
    s_add_u32 s51, s10, 28672
    s_and_b32 s51, s51, 0x7fff
    s_add_u32 s48, s64, s51
    buffer_load_dwordx4 v[152:155], v9, s[36:39], s48 offen offset:0 sc1
    ds_read_b128 v[32:35], v0 offset:31744
    s_waitcnt lgkmcnt(2)
    v_mfma_f32_32x32x16_bf16 v[12:27], v[156:159], v[36:39], v[12:27]
    buffer_load_dwordx4 v[156:159], v9, s[36:39], s48 offen offset:1024 sc1
    s_waitcnt lgkmcnt(1)
    v_mfma_f32_32x32x16_bf16 v[12:27], v[160:163], v[28:31], v[12:27]
    buffer_load_dwordx4 v[160:163], v9, s[36:39], s48 offen offset:2048 sc1
    s_waitcnt lgkmcnt(0)
    v_mfma_f32_32x32x16_bf16 v[12:27], v[164:167], v[32:35], v[12:27]
    buffer_load_dwordx4 v[164:167], v9, s[36:39], s48 offen offset:3072 sc1
    s_waitcnt vmcnt(0)
    s_nop 9
    v_cvt_pk_bf16_f32 v28, v12, v13
    v_cvt_pk_bf16_f32 v29, v14, v15
    v_cvt_pk_bf16_f32 v30, v16, v17
    v_cvt_pk_bf16_f32 v31, v18, v19
    ds_write_b128 v8, v[28:31]
    v_cvt_pk_bf16_f32 v32, v20, v21
    v_cvt_pk_bf16_f32 v33, v22, v23
    v_cvt_pk_bf16_f32 v34, v24, v25
    v_cvt_pk_bf16_f32 v35, v26, v27
    ds_write_b128 v8, v[32:35] offset:32
    ds_read_b128 v[12:15], v3
    ds_read_b128 v[16:19], v3 offset:1280
    s_waitcnt lgkmcnt(1)
    buffer_store_dwordx4 v[12:15], v4, s[28:31], s47 offen offset:1024 nt
    s_waitcnt lgkmcnt(0)
    buffer_store_dwordx4 v[16:19], v4, s[28:31], s56 offen offset:1024 nt
b_tail:
    s_or_b32 s51, s2, s26
    s_cmp_eq_u32 s51, 0
    s_cbranch_scc0 ep_74
    s_mov_b32 s51, 258048
    v_mov_b32 v28, s62
    v_mov_b32 v29, 0
    s_mov_b64 exec, 1
    buffer_store_dword v28, v29, s[36:39], s51 offen sc1
    s_mov_b64 exec, -1
ep_74:
    v_add_u32 v0, 65536, v9
lw_75:
    ds_read_b32 v5, v10 offset:112
    s_waitcnt lgkmcnt(0)
    v_readfirstlane_b32 s51, v5
    s_nop 0
    s_cmp_ge_u32 s51, 1
    s_cbranch_scc1 lwd_76
    s_sleep 16
    s_branch lw_75
lwd_76:
lw_77:
    ds_read_b32 v5, v10 offset:144
    s_waitcnt lgkmcnt(0)
    v_readfirstlane_b32 s51, v5
    s_nop 0
    s_cmp_ge_u32 s51, 8
    s_cbranch_scc1 lwd_78
    s_branch lw_77
lwd_78:
    ds_read_b128 v[28:31], v0 offset:0
    ds_read_b128 v[32:35], v0 offset:1024
    ds_read_b128 v[36:39], v0 offset:2048
    s_waitcnt lgkmcnt(2)
    v_mfma_f32_32x32x16_bf16 v[12:27], v[40:43], v[28:31], 0
    ds_read_b128 v[28:31], v0 offset:3072
    s_waitcnt lgkmcnt(2)
    v_mfma_f32_32x32x16_bf16 v[12:27], v[44:47], v[32:35], v[12:27]
    ds_read_b128 v[32:35], v0 offset:4096
    s_waitcnt lgkmcnt(2)
    v_mfma_f32_32x32x16_bf16 v[12:27], v[48:51], v[36:39], v[12:27]
    ds_read_b128 v[36:39], v0 offset:5120
    s_waitcnt lgkmcnt(2)
    v_mfma_f32_32x32x16_bf16 v[12:27], v[52:55], v[28:31], v[12:27]
    ds_read_b128 v[28:31], v0 offset:6144
    s_waitcnt lgkmcnt(2)
    v_mfma_f32_32x32x16_bf16 v[12:27], v[56:59], v[32:35], v[12:27]
    ds_read_b128 v[32:35], v0 offset:7168
    s_waitcnt lgkmcnt(2)
    v_mfma_f32_32x32x16_bf16 v[12:27], v[60:63], v[36:39], v[12:27]
    s_waitcnt lgkmcnt(1)
    v_mfma_f32_32x32x16_bf16 v[12:27], v[64:67], v[28:31], v[12:27]
    s_waitcnt lgkmcnt(0)
    v_mfma_f32_32x32x16_bf16 v[12:27], v[68:71], v[32:35], v[12:27]
lw_79:
    ds_read_b32 v5, v10 offset:148
    s_waitcnt lgkmcnt(0)
    v_readfirstlane_b32 s51, v5
    s_nop 0
    s_cmp_ge_u32 s51, 8
    s_cbranch_scc1 lwd_80
    s_branch lw_79
lwd_80:
    ds_read_b128 v[40:43], v0 offset:8192
    ds_read_b128 v[44:47], v0 offset:9216
    ds_read_b128 v[48:51], v0 offset:10240
    ds_read_b128 v[52:55], v0 offset:11264
    ds_read_b128 v[56:59], v0 offset:12288
    ds_read_b128 v[60:63], v0 offset:13312
    ds_read_b128 v[64:67], v0 offset:14336
    ds_read_b128 v[68:71], v0 offset:15360
    s_waitcnt lgkmcnt(7)
    v_mfma_f32_32x32x16_bf16 v[12:27], v[72:75], v[40:43], v[12:27]
    ds_read_b64 v[28:29], v10 offset:152
    s_waitcnt lgkmcnt(6)
    v_mfma_f32_32x32x16_bf16 v[12:27], v[76:79], v[44:47], v[12:27]
    s_waitcnt lgkmcnt(5)
    v_mfma_f32_32x32x16_bf16 v[12:27], v[80:83], v[48:51], v[12:27]
    s_waitcnt lgkmcnt(0)
    v_min_u32 v28, v28, v29
    s_nop 0
    v_readfirstlane_b32 s51, v28
    s_nop 0
    s_cmp_ge_u32 s51, 8
    s_cbranch_scc0 b_slowtail
    ds_read_b128 v[72:75], v0 offset:16384
    ds_read_b128 v[76:79], v0 offset:17408
    ds_read_b128 v[80:83], v0 offset:18432
    v_mfma_f32_32x32x16_bf16 v[12:27], v[84:87], v[52:55], v[12:27]
    ds_read_b128 v[84:87], v0 offset:19456
    v_mfma_f32_32x32x16_bf16 v[12:27], v[88:91], v[56:59], v[12:27]
    ds_read_b128 v[88:91], v0 offset:20480
    v_mfma_f32_32x32x16_bf16 v[12:27], v[92:95], v[60:63], v[12:27]
    ds_read_b128 v[92:95], v0 offset:21504
    v_mfma_f32_32x32x16_bf16 v[12:27], v[96:99], v[64:67], v[12:27]
    ds_read_b128 v[96:99], v0 offset:22528
    v_mfma_f32_32x32x16_bf16 v[12:27], v[100:103], v[68:71], v[12:27]
    ds_read_b128 v[100:103], v0 offset:23552
    s_waitcnt lgkmcnt(7)
    v_mfma_f32_32x32x16_bf16 v[12:27], v[104:107], v[72:75], v[12:27]
    ds_read_b128 v[104:107], v0 offset:24576
    s_waitcnt lgkmcnt(7)
    v_mfma_f32_32x32x16_bf16 v[12:27], v[108:111], v[76:79], v[12:27]
    ds_read_b128 v[108:111], v0 offset:25600
    s_waitcnt lgkmcnt(7)
    v_mfma_f32_32x32x16_bf16 v[12:27], v[112:115], v[80:83], v[12:27]
    ds_read_b128 v[112:115], v0 offset:26624
    s_waitcnt lgkmcnt(7)
    v_mfma_f32_32x32x16_bf16 v[12:27], v[116:119], v[84:87], v[12:27]
    ds_read_b128 v[116:119], v0 offset:27648
    s_waitcnt lgkmcnt(7)
    v_mfma_f32_32x32x16_bf16 v[12:27], v[120:123], v[88:91], v[12:27]
    ds_read_b128 v[120:123], v0 offset:28672
    s_waitcnt lgkmcnt(7)
    v_mfma_f32_32x32x16_bf16 v[12:27], v[124:127], v[92:95], v[12:27]
    ds_read_b128 v[124:127], v0 offset:29696
    s_waitcnt lgkmcnt(7)
    v_mfma_f32_32x32x16_bf16 v[12:27], v[128:131], v[96:99], v[12:27]
    ds_read_b128 v[128:131], v0 offset:30720
    s_waitcnt lgkmcnt(7)
    v_mfma_f32_32x32x16_bf16 v[12:27], v[132:135], v[100:103], v[12:27]
    ds_read_b128 v[132:135], v0 offset:31744
    s_waitcnt lgkmcnt(7)
    v_mfma_f32_32x32x16_bf16 v[12:27], v[136:139], v[104:107], v[12:27]
    s_waitcnt lgkmcnt(6)
    v_mfma_f32_32x32x16_bf16 v[12:27], v[140:143], v[108:111], v[12:27]
    s_waitcnt lgkmcnt(5)
    v_mfma_f32_32x32x16_bf16 v[12:27], v[144:147], v[112:115], v[12:27]
    s_waitcnt lgkmcnt(4)
    v_mfma_f32_32x32x16_bf16 v[12:27], v[148:151], v[116:119], v[12:27]
    s_waitcnt lgkmcnt(3)
    v_mfma_f32_32x32x16_bf16 v[12:27], v[152:155], v[120:123], v[12:27]
    s_waitcnt lgkmcnt(2)
    v_mfma_f32_32x32x16_bf16 v[12:27], v[156:159], v[124:127], v[12:27]
    s_waitcnt lgkmcnt(1)
    v_mfma_f32_32x32x16_bf16 v[12:27], v[160:163], v[128:131], v[12:27]
    s_waitcnt lgkmcnt(0)
    v_mfma_f32_32x32x16_bf16 v[12:27], v[164:167], v[132:135], v[12:27]
b_fin:
    s_nop 11
    v_cvt_pk_bf16_f32 v28, v12, v13
    v_cvt_pk_bf16_f32 v29, v14, v15
    v_cvt_pk_bf16_f32 v30, v16, v17
    v_cvt_pk_bf16_f32 v31, v18, v19
    ds_write_b128 v8, v[28:31]
    v_cvt_pk_bf16_f32 v32, v20, v21
    v_cvt_pk_bf16_f32 v33, v22, v23
    v_cvt_pk_bf16_f32 v34, v24, v25
    v_cvt_pk_bf16_f32 v35, v26, v27
    ds_write_b128 v8, v[32:35] offset:32
    ds_read_b128 v[12:15], v3
    ds_read_b128 v[16:19], v3 offset:1280
    s_waitcnt lgkmcnt(1)
    buffer_store_dwordx4 v[12:15], v4, s[28:31], s47 offen offset:0 nt
    s_waitcnt lgkmcnt(0)
    buffer_store_dwordx4 v[16:19], v4, s[28:31], s56 offen offset:0 nt
    s_endpgm
b_slowtail:
    s_waitcnt lgkmcnt(4)
    v_mfma_f32_32x32x16_bf16 v[12:27], v[84:87], v[52:55], v[12:27]
    s_waitcnt lgkmcnt(3)
    v_mfma_f32_32x32x16_bf16 v[12:27], v[88:91], v[56:59], v[12:27]
    s_waitcnt lgkmcnt(2)
    v_mfma_f32_32x32x16_bf16 v[12:27], v[92:95], v[60:63], v[12:27]
    s_waitcnt lgkmcnt(1)
    v_mfma_f32_32x32x16_bf16 v[12:27], v[96:99], v[64:67], v[12:27]
    s_waitcnt lgkmcnt(0)
    v_mfma_f32_32x32x16_bf16 v[12:27], v[100:103], v[68:71], v[12:27]
lw_81:
    ds_read_b32 v5, v10 offset:152
    s_waitcnt lgkmcnt(0)
    v_readfirstlane_b32 s51, v5
    s_nop 0
    s_cmp_ge_u32 s51, 8
    s_cbranch_scc1 lwd_82
    s_branch lw_81
lwd_82:
    ds_read_b128 v[72:75], v0 offset:16384
    ds_read_b128 v[76:79], v0 offset:17408
    ds_read_b128 v[80:83], v0 offset:18432
    ds_read_b128 v[84:87], v0 offset:19456
    ds_read_b128 v[88:91], v0 offset:20480
    ds_read_b128 v[92:95], v0 offset:21504
    ds_read_b128 v[96:99], v0 offset:22528
    ds_read_b128 v[100:103], v0 offset:23552
    s_waitcnt lgkmcnt(7)
    v_mfma_f32_32x32x16_bf16 v[12:27], v[104:107], v[72:75], v[12:27]
    s_waitcnt lgkmcnt(6)
    v_mfma_f32_32x32x16_bf16 v[12:27], v[108:111], v[76:79], v[12:27]
    s_waitcnt lgkmcnt(5)
    v_mfma_f32_32x32x16_bf16 v[12:27], v[112:115], v[80:83], v[12:27]
    s_waitcnt lgkmcnt(4)
    v_mfma_f32_32x32x16_bf16 v[12:27], v[116:119], v[84:87], v[12:27]
    s_waitcnt lgkmcnt(3)
    v_mfma_f32_32x32x16_bf16 v[12:27], v[120:123], v[88:91], v[12:27]
    s_waitcnt lgkmcnt(2)
    v_mfma_f32_32x32x16_bf16 v[12:27], v[124:127], v[92:95], v[12:27]
    s_waitcnt lgkmcnt(1)
    v_mfma_f32_32x32x16_bf16 v[12:27], v[128:131], v[96:99], v[12:27]
    s_waitcnt lgkmcnt(0)
    v_mfma_f32_32x32x16_bf16 v[12:27], v[132:135], v[100:103], v[12:27]
lw_83:
    ds_read_b32 v5, v10 offset:156
    s_waitcnt lgkmcnt(0)
    v_readfirstlane_b32 s51, v5
    s_nop 0
    s_cmp_ge_u32 s51, 8
    s_cbranch_scc1 lwd_84
    s_branch lw_83
lwd_84:
    ds_read_b128 v[104:107], v0 offset:24576
    ds_read_b128 v[108:111], v0 offset:25600
    ds_read_b128 v[112:115], v0 offset:26624
    ds_read_b128 v[116:119], v0 offset:27648
    ds_read_b128 v[120:123], v0 offset:28672
    ds_read_b128 v[124:127], v0 offset:29696
    ds_read_b128 v[128:131], v0 offset:30720
    ds_read_b128 v[132:135], v0 offset:31744
    s_waitcnt lgkmcnt(7)
    v_mfma_f32_32x32x16_bf16 v[12:27], v[136:139], v[104:107], v[12:27]
    s_waitcnt lgkmcnt(6)
    v_mfma_f32_32x32x16_bf16 v[12:27], v[140:143], v[108:111], v[12:27]
    s_waitcnt lgkmcnt(5)
    v_mfma_f32_32x32x16_bf16 v[12:27], v[144:147], v[112:115], v[12:27]
    s_waitcnt lgkmcnt(4)
    v_mfma_f32_32x32x16_bf16 v[12:27], v[148:151], v[116:119], v[12:27]
    s_waitcnt lgkmcnt(3)
    v_mfma_f32_32x32x16_bf16 v[12:27], v[152:155], v[120:123], v[12:27]
    s_waitcnt lgkmcnt(2)
    v_mfma_f32_32x32x16_bf16 v[12:27], v[156:159], v[124:127], v[12:27]
    s_waitcnt lgkmcnt(1)
    v_mfma_f32_32x32x16_bf16 v[12:27], v[160:163], v[128:131], v[12:27]
    s_waitcnt lgkmcnt(0)
    v_mfma_f32_32x32x16_bf16 v[12:27], v[164:167], v[132:135], v[12:27]
    s_branch b_fin
k_exit:
    s_endpgm
.section .rodata,"a"
.p2align 6
.amdhsa_kernel concat_heads__grouped_kv_mqa__sliding_local_dilated__prompt_kernel
  .amdhsa_next_free_vgpr 168
  .amdhsa_next_free_sgpr 100
  .amdhsa_accum_offset 168
  .amdhsa_group_segment_fixed_size 0
  .amdhsa_kernarg_size 88
  .amdhsa_user_sgpr_count 2
  .amdhsa_user_sgpr_kernarg_segment_ptr 1
  .amdhsa_system_sgpr_workgroup_id_x 1
.end_amdhsa_kernel
```
